```python
import torch

def _softmax(x, axis=-1):
    return torch.softmax(x, dim=axis)
def _gelu(x):
    return torch.nn.functional.gelu(x, approximate="tanh")
def _silu(x):
    return torch.nn.functional.silu(x)
def _sigmoid(x):
    return torch.sigmoid(x)
def _layernorm(x, axis=-1, eps=1e-5):
    m = x.mean(dim=axis, keepdim=True)
    v = x.var(dim=axis, keepdim=True, unbiased=False)
    return (x - m) / torch.sqrt(v + eps)
def _scatter_add(tgt, idx, src, axis=0):
    return tgt.clone().index_add_(axis, idx, src)
def _segment_sum(src, seg, n):
    out = torch.zeros((n,) + src.shape[1:], dtype=src.dtype)
    return out.index_add_(0, seg, src)
def _pad(x, pw):
    flat = tuple(v for pair in reversed(pw) for v in pair)
    return torch.nn.functional.pad(x, flat)

kernel_name = 'recurrent_scan__spectral_fnet__glu_gated_bilinear__prompt'

def setup_inputs():

    _w = (lambda a: (lambda t: t.to(torch.bfloat16) if t.is_floating_point() else t)(torch.as_tensor(a)))
    def _A_setup():
        B, S, D = 1, 2048, 512
        ns = torch.arange(S)[:, None] * torch.arange(S)[None, :]
        nd = torch.arange(D)[:, None] * torch.arange(D)[None, :]
        Ws_re = torch.cos(-2.0 * torch.pi * ns / S).to(float)
        Ws_im = torch.sin(-2.0 * torch.pi * ns / S).to(float)
        Wd_re = torch.cos(-2.0 * torch.pi * nd / D).to(float)
        Wd_im = torch.sin(-2.0 * torch.pi * nd / D).to(float)
        return {
            "x": _w((lambda *s: torch.randn(*s, dtype=torch.bfloat16) * 0.05)(B, S, D)),
            "dft_seq_re": _w(Ws_re),
            "dft_seq_im": _w(Ws_im),
            "dft_hid_re": _w(Wd_re),
            "dft_hid_im": _w(Wd_im),
        }
    _A_in = _A_setup()

    def _B_setup():
        B, S, D, F = 1, 2048, 512, 1376
        return {
            "x": _w((lambda *s: torch.randn(*s, dtype=torch.bfloat16) * 0.05)(B, S, D)),
            "w_gate": _w((lambda *s: torch.randn(*s, dtype=torch.bfloat16) * 0.05)(D, F) * (D ** -0.5)),
            "w_up": _w((lambda *s: torch.randn(*s, dtype=torch.bfloat16) * 0.05)(D, F) * (D ** -0.5)),
            "w_down": _w((lambda *s: torch.randn(*s, dtype=torch.bfloat16) * 0.05)(F, D) * (F ** -0.5)),
        }
    _B_in = _B_setup()

    return {
        "A_x": _A_in["x"],
        "A_dft_seq_re": _A_in["dft_seq_re"],
        "A_dft_seq_im": _A_in["dft_seq_im"],
        "A_dft_hid_re": _A_in["dft_hid_re"],
        "A_dft_hid_im": _A_in["dft_hid_im"],
        "B_x": _B_in["x"],
        "B_w_gate": _B_in["w_gate"],
        "B_w_up": _B_in["w_up"],
        "B_w_down": _B_in["w_down"],
    }

def reference(A_x, A_dft_seq_re, A_dft_seq_im, A_dft_hid_re, A_dft_hid_im, B_x, B_w_gate, B_w_up, B_w_down):
    def _A_ref(x, dft_seq_re, dft_seq_im, dft_hid_re, dft_hid_im):
        a = torch.einsum("bsd,ed->bse", x, dft_hid_re)
        b = torch.einsum("bsd,ed->bse", x, dft_hid_im)
        y = torch.einsum("ts,bse->bte", dft_seq_re, a) - torch.einsum("ts,bse->bte", dft_seq_im, b)
        return y

    def _B_ref(x, w_gate, w_up, w_down):
        g = torch.einsum("bsd,df->bsf", x, w_gate)
        u = torch.einsum("bsd,df->bsf", x, w_up)
        h = g * u
        return torch.einsum("bsf,fd->bsd", h, w_down)

    x = A_x
    xn = _layernorm(x, axis=-1)
    s = _A_ref(xn, A_dft_seq_re, A_dft_seq_im, A_dft_hid_re, A_dft_hid_im)
    g = _silu(_B_ref(xn, B_w_gate, B_w_up, B_w_down))
    return x + s * g
```

```asm
; @launch grid=(256,1,1) block=(512,1,1) lds=163840
.amdgcn_target "amdgcn-amd-amdhsa--gfx950"
.text
.globl recurrent_scan__spectral_fnet__glu_gated_bilinear__prompt_kernel
.p2align 8
.type recurrent_scan__spectral_fnet__glu_gated_bilinear__prompt_kernel,@function
recurrent_scan__spectral_fnet__glu_gated_bilinear__prompt_kernel:
K_start:
    s_cmp_ge_u32 s2, 256
    s_cbranch_scc1 K_end
    s_load_dwordx2 s[4:5], s[0:1], 0
    s_load_dwordx4 s[12:15], s[0:1], 48
    s_load_dwordx2 s[6:7], s[0:1], 88
    s_load_dwordx4 s[56:59], s[0:1], 64
    v_lshrrev_b32 v2, 6, v0
    v_and_b32 v1, 63, v0
    s_and_b32 s18, s2, 7
    s_lshr_b32 s17, s2, 3
    v_readfirstlane_b32 s19, v2
    s_lshr_b32 s8, s17, 4
    s_and_b32 s17, s17, 15
    s_lshl_b32 s16, s18, 1
    s_add_u32 s16, s16, s8
    s_and_b32 s46, s19, 3
    v_lshlrev_b32 v63, 4, v1
    s_cmp_lt_u32 s19, 4
    s_cbranch_scc1 K_compute
    s_cmp_eq_u32 s46, 0
    s_cbranch_scc1 K_xl
    s_cmp_eq_u32 s46, 3
    s_cbranch_scc1 K_help
    s_min_u32 s44, s17, 6
    s_mul_i32 s20, s17, 5
    s_add_u32 s20, s20, s44
    s_cmp_lt_u32 s17, 6
    s_cselect_b32 s21, 6, 5
    s_sub_u32 s47, s46, 1
    v_lshrrev_b32 v44, 4, v1
    v_and_b32 v45, 15, v1
    s_lshl_b32 s44, s47, 3
    v_add_u32 v42, s44, v44
    v_mul_u32_u24 v42, 2752, v42
    v_and_b32 v43, 1, v45
    v_lshl_add_u32 v42, v43, 4, v42
    v_lshrrev_b32 v45, 1, v45
    v_mov_b32 v46, 1073741824
    v_lshlrev_b32 v44, 1, v44
    v_xor_b32 v44, v44, v45
    v_cmp_gt_u32 vcc, s21, v44
    v_add_u32 v43, s20, v44
    v_lshl_add_u32 v43, v43, 5, v42
    v_cndmask_b32 v43, v46, v43, vcc
    v_add_u32 v12, 3072, v43
    v_add_u32 v14, 45056, v43
    v_add_u32 v16, 91136, v43
    v_add_u32 v18, 133120, v43
    v_xor_b32 v44, 1, v44
    v_cmp_gt_u32 vcc, s21, v44
    v_add_u32 v43, s20, v44
    v_lshl_add_u32 v43, v43, 5, v42
    v_cndmask_b32 v43, v46, v43, vcc
    v_add_u32 v13, 2048, v43
    v_add_u32 v15, 48128, v43
    v_add_u32 v17, 90112, v43
    v_add_u32 v19, 136192, v43
    s_mul_i32 s49, s47, 26624
    s_waitcnt lgkmcnt(0)
    s_sub_u32 s32, s12, 4096
    s_subb_u32 s33, s13, 0
    s_mov_b32 s34, 1413120
    s_mov_b32 s35, 0x20000
    s_sub_u32 s36, s14, 4096
    s_subb_u32 s37, s15, 0
    s_mov_b32 s38, 1413120
    s_mov_b32 s39, 0x20000
    s_mul_i32 s51, s18, 176128
    s_add_u32 s52, s51, 11008
    s_add_u32 m0, s49, 4096
    s_nop 0
    buffer_load_dwordx4 v12, s[32:35], s51 offen offset:1024 lds
    buffer_load_dwordx4 v13, s[36:39], s51 offen offset:2048 lds
    s_add_u32 m0, s49, 17408
    s_nop 0
    buffer_load_dwordx4 v12, s[32:35], s52 offen offset:1024 lds
    buffer_load_dwordx4 v13, s[36:39], s52 offen offset:2048 lds
    s_add_u32 m0, s49, 4096
    s_nop 0
    buffer_load_dwordx4 v14, s[32:35], s51 offen offset:3072 lds
    s_add_u32 m0, s49, 8192
    s_nop 0
    buffer_load_dwordx4 v15, s[36:39], s51 offen lds
    s_add_u32 m0, s49, 17408
    s_nop 0
    buffer_load_dwordx4 v14, s[32:35], s52 offen offset:3072 lds
    s_add_u32 m0, s49, 21504
    s_nop 0
    buffer_load_dwordx4 v15, s[36:39], s52 offen lds
    s_add_u32 m0, s49, 8192
    s_nop 0
    buffer_load_dwordx4 v16, s[32:35], s51 offen offset:1024 lds
    buffer_load_dwordx4 v17, s[36:39], s51 offen offset:2048 lds
    s_add_u32 m0, s49, 21504
    s_nop 0
    buffer_load_dwordx4 v16, s[32:35], s52 offen offset:1024 lds
    buffer_load_dwordx4 v17, s[36:39], s52 offen offset:2048 lds
    s_add_u32 m0, s49, 8192
    s_nop 0
    buffer_load_dwordx4 v18, s[32:35], s51 offen offset:3072 lds
    s_add_u32 m0, s49, 12288
    s_nop 0
    buffer_load_dwordx4 v19, s[36:39], s51 offen lds
    s_add_u32 m0, s49, 21504
    s_nop 0
    buffer_load_dwordx4 v18, s[32:35], s52 offen offset:3072 lds
    s_add_u32 m0, s49, 25600
    s_nop 0
    buffer_load_dwordx4 v19, s[36:39], s52 offen lds
    s_add_u32 s49, s49, 53248
    s_cmp_ge_u32 s49, 159744
    s_cselect_b32 s53, 159744, 0
    s_sub_u32 s49, s49, s53
    s_add_u32 s18, s18, 1
    s_and_b32 s18, s18, 7
    s_mul_i32 s51, s18, 176128
    s_add_u32 s52, s51, 11008
    s_add_u32 m0, s49, 4096
    s_nop 0
    buffer_load_dwordx4 v12, s[32:35], s51 offen offset:1024 lds
    buffer_load_dwordx4 v13, s[36:39], s51 offen offset:2048 lds
    s_add_u32 m0, s49, 17408
    s_nop 0
    buffer_load_dwordx4 v12, s[32:35], s52 offen offset:1024 lds
    buffer_load_dwordx4 v13, s[36:39], s52 offen offset:2048 lds
    s_add_u32 m0, s49, 4096
    s_nop 0
    buffer_load_dwordx4 v14, s[32:35], s51 offen offset:3072 lds
    s_add_u32 m0, s49, 8192
    s_nop 0
    buffer_load_dwordx4 v15, s[36:39], s51 offen lds
    s_add_u32 m0, s49, 17408
    s_nop 0
    buffer_load_dwordx4 v14, s[32:35], s52 offen offset:3072 lds
    s_add_u32 m0, s49, 21504
    s_nop 0
    buffer_load_dwordx4 v15, s[36:39], s52 offen lds
    s_add_u32 m0, s49, 8192
    s_nop 0
    buffer_load_dwordx4 v16, s[32:35], s51 offen offset:1024 lds
    buffer_load_dwordx4 v17, s[36:39], s51 offen offset:2048 lds
    s_add_u32 m0, s49, 21504
    s_nop 0
    buffer_load_dwordx4 v16, s[32:35], s52 offen offset:1024 lds
    buffer_load_dwordx4 v17, s[36:39], s52 offen offset:2048 lds
    s_mov_b32 s48, 6
    s_waitcnt vmcnt(12)
    s_barrier
    s_add_u32 m0, s49, 8192
    s_nop 0
    buffer_load_dwordx4 v18, s[32:35], s51 offen offset:3072 lds
    s_add_u32 m0, s49, 12288
    s_nop 0
    buffer_load_dwordx4 v19, s[36:39], s51 offen lds
    s_add_u32 m0, s49, 21504
    s_nop 0
    buffer_load_dwordx4 v18, s[32:35], s52 offen offset:3072 lds
    s_add_u32 m0, s49, 25600
    s_nop 0
    buffer_load_dwordx4 v19, s[36:39], s52 offen lds
    s_add_u32 s49, s49, 53248
    s_cmp_ge_u32 s49, 159744
    s_cselect_b32 s53, 159744, 0
    s_sub_u32 s49, s49, s53
    s_add_u32 s18, s18, 1
    s_and_b32 s18, s18, 7
K_wloop:
    s_mul_i32 s51, s18, 176128
    s_add_u32 s52, s51, 11008
    s_add_u32 m0, s49, 4096
    s_nop 0
    buffer_load_dwordx4 v12, s[32:35], s51 offen offset:1024 lds
    buffer_load_dwordx4 v13, s[36:39], s51 offen offset:2048 lds
    s_add_u32 m0, s49, 17408
    s_nop 0
    buffer_load_dwordx4 v12, s[32:35], s52 offen offset:1024 lds
    buffer_load_dwordx4 v13, s[36:39], s52 offen offset:2048 lds
    s_add_u32 m0, s49, 4096
    s_nop 0
    buffer_load_dwordx4 v14, s[32:35], s51 offen offset:3072 lds
    s_add_u32 m0, s49, 8192
    s_nop 0
    buffer_load_dwordx4 v15, s[36:39], s51 offen lds
    s_add_u32 m0, s49, 17408
    s_nop 0
    buffer_load_dwordx4 v14, s[32:35], s52 offen offset:3072 lds
    s_add_u32 m0, s49, 21504
    s_nop 0
    buffer_load_dwordx4 v15, s[36:39], s52 offen lds
    s_add_u32 m0, s49, 8192
    s_nop 0
    buffer_load_dwordx4 v16, s[32:35], s51 offen offset:1024 lds
    buffer_load_dwordx4 v17, s[36:39], s51 offen offset:2048 lds
    s_add_u32 m0, s49, 21504
    s_nop 0
    buffer_load_dwordx4 v16, s[32:35], s52 offen offset:1024 lds
    buffer_load_dwordx4 v17, s[36:39], s52 offen offset:2048 lds
    s_add_u32 m0, s49, 8192
    s_nop 0
    buffer_load_dwordx4 v18, s[32:35], s51 offen offset:3072 lds
    s_add_u32 m0, s49, 12288
    s_nop 0
    buffer_load_dwordx4 v19, s[36:39], s51 offen lds
    s_add_u32 m0, s49, 21504
    s_nop 0
    buffer_load_dwordx4 v18, s[32:35], s52 offen offset:3072 lds
    s_add_u32 m0, s49, 25600
    s_nop 0
    buffer_load_dwordx4 v19, s[36:39], s52 offen lds
    s_add_u32 s49, s49, 53248
    s_cmp_ge_u32 s49, 159744
    s_cselect_b32 s53, 159744, 0
    s_sub_u32 s49, s49, s53
    s_add_u32 s18, s18, 1
    s_and_b32 s18, s18, 7
    s_waitcnt vmcnt(16)
    s_barrier
    s_sub_u32 s48, s48, 1
    s_cmp_lg_u32 s48, 0
    s_cbranch_scc1 K_wloop
    s_and_b32 s22, s17, 7
    v_lshrrev_b32 v40, 3, v1
    v_and_b32 v41, 7, v1
    v_lshlrev_b32 v43, 1, v40
    v_and_b32 v43, 4, v43
    v_xor_b32 v43, v43, v41
    v_lshlrev_b32 v43, 4, v43
    v_lshl_add_u32 v43, v40, 10, v43
    s_lshl_b32 s45, s22, 7
    v_add_u32 v20, s45, v43
    v_add_u32 v21, 7168, v20
    s_mul_i32 s60, s47, 704512
    s_mul_i32 s55, s47, 26624
    s_mov_b32 s96, s56
    s_mov_b32 s97, s57
    s_mov_b32 s98, 1409024
    s_mov_b32 s99, 0x20000
    s_add_u32 s44, s55, 106496
    s_mov_b32 s48, 10
K_wp0:
    s_mov_b32 m0, s44
    s_add_u32 s44, s44, 2048
    buffer_load_dwordx4 v20, s[96:99], s60 offen lds
    buffer_load_dwordx4 v21, s[96:99], s60 offen offset:1024 lds
    s_add_u32 s60, s60, 16384
    s_sub_u32 s48, s48, 1
    s_cmp_lg_u32 s48, 0
    s_cbranch_scc1 K_wp0
    s_waitcnt vmcnt(20)
    s_barrier
    s_add_u32 s44, s55, 126976
    s_mov_b32 s48, 3
K_wp1:
    s_mov_b32 m0, s44
    s_add_u32 s44, s44, 2048
    buffer_load_dwordx4 v20, s[96:99], s60 offen lds
    buffer_load_dwordx4 v21, s[96:99], s60 offen offset:1024 lds
    s_add_u32 s60, s60, 16384
    s_sub_u32 s48, s48, 1
    s_cmp_lg_u32 s48, 0
    s_cbranch_scc1 K_wp1
    s_add_u32 s44, s55, 0
    s_mov_b32 s48, 7
K_wp2:
    s_mov_b32 m0, s44
    s_add_u32 s44, s44, 2048
    buffer_load_dwordx4 v20, s[96:99], s60 offen lds
    buffer_load_dwordx4 v21, s[96:99], s60 offen offset:1024 lds
    s_add_u32 s60, s60, 16384
    s_sub_u32 s48, s48, 1
    s_cmp_lg_u32 s48, 0
    s_cbranch_scc1 K_wp2
    s_waitcnt vmcnt(28)
    s_barrier
    s_add_u32 s44, s55, 14336
    s_mov_b32 s48, 6
K_wp3:
    s_mov_b32 m0, s44
    s_add_u32 s44, s44, 2048
    buffer_load_dwordx4 v20, s[96:99], s60 offen lds
    buffer_load_dwordx4 v21, s[96:99], s60 offen offset:1024 lds
    s_add_u32 s60, s60, 16384
    s_sub_u32 s48, s48, 1
    s_cmp_lg_u32 s48, 0
    s_cbranch_scc1 K_wp3
    s_waitcnt vmcnt(0)
    s_barrier
    s_add_u32 s44, s55, 53248
    s_mov_b32 s48, 11
K_wp4:
    s_mov_b32 m0, s44
    s_add_u32 s44, s44, 2048
    buffer_load_dwordx4 v20, s[96:99], s60 offen lds
    buffer_load_dwordx4 v21, s[96:99], s60 offen offset:1024 lds
    s_add_u32 s60, s60, 16384
    s_sub_u32 s48, s48, 1
    s_cmp_lg_u32 s48, 0
    s_cbranch_scc1 K_wp4
    s_add_u32 s44, s55, 106496
    s_mov_b32 s48, 6
K_wp5:
    s_mov_b32 m0, s44
    s_add_u32 s44, s44, 2048
    buffer_load_dwordx4 v20, s[96:99], s60 offen lds
    buffer_load_dwordx4 v21, s[96:99], s60 offen offset:1024 lds
    s_add_u32 s60, s60, 16384
    s_sub_u32 s48, s48, 1
    s_cmp_lg_u32 s48, 0
    s_cbranch_scc1 K_wp5
    s_lshl_b32 s44, s47, 2
    s_add_u32 s44, s44, 163344
    s_waitcnt vmcnt(0)
    v_mov_b32 v32, s44
    v_mov_b32 v33, 1
    ds_write_b32 v32, v33
    s_endpgm
K_xl:
    v_lshrrev_b32 v40, 3, v1
    v_and_b32 v41, 7, v1
    v_lshrrev_b32 v43, 1, v40
    v_xor_b32 v43, v43, v41
    v_lshlrev_b32 v42, 16, v40
    s_lshl_b32 s44, s16, 11
    v_add_u32 v42, s44, v42
    v_lshl_add_u32 v12, v43, 4, v42
    v_xor_b32 v13, 64, v12
    v_add_u32 v14, 1046528, v12
    v_add_u32 v15, 1569792, v13
    v_add_u32 v13, 523264, v13
    s_mov_b32 s49, 0
    s_waitcnt lgkmcnt(0)
    s_mov_b32 s24, s4
    s_mov_b32 s25, s5
    s_mov_b32 s26, 2097152
    s_mov_b32 s27, 0x20000
    s_lshl_b32 s52, s18, 7
    s_add_u32 m0, s49, 0
    s_add_u32 s51, s52, 0
    buffer_load_dwordx4 v12, s[24:27], s51 offen lds
    buffer_load_dwordx4 v13, s[24:27], s51 offen offset:1024 lds
    buffer_load_dwordx4 v14, s[24:27], s51 offen offset:2048 lds
    buffer_load_dwordx4 v15, s[24:27], s51 offen offset:3072 lds
    s_add_u32 m0, s49, 13312
    s_add_u32 s51, s52, 1024
    buffer_load_dwordx4 v12, s[24:27], s51 offen lds
    buffer_load_dwordx4 v13, s[24:27], s51 offen offset:1024 lds
    buffer_load_dwordx4 v14, s[24:27], s51 offen offset:2048 lds
    buffer_load_dwordx4 v15, s[24:27], s51 offen offset:3072 lds
    s_add_u32 m0, s49, 26624
    s_add_u32 s51, s52, 32768
    buffer_load_dwordx4 v12, s[24:27], s51 offen lds
    buffer_load_dwordx4 v13, s[24:27], s51 offen offset:1024 lds
    buffer_load_dwordx4 v14, s[24:27], s51 offen offset:2048 lds
    buffer_load_dwordx4 v15, s[24:27], s51 offen offset:3072 lds
    s_add_u32 m0, s49, 39936
    s_add_u32 s51, s52, 33792
    buffer_load_dwordx4 v12, s[24:27], s51 offen lds
    buffer_load_dwordx4 v13, s[24:27], s51 offen offset:1024 lds
    buffer_load_dwordx4 v14, s[24:27], s51 offen offset:2048 lds
    buffer_load_dwordx4 v15, s[24:27], s51 offen offset:3072 lds
    s_add_u32 s49, s49, 53248
    s_cmp_ge_u32 s49, 159744
    s_cselect_b32 s53, 159744, 0
    s_sub_u32 s49, s49, s53
    s_add_u32 s18, s18, 1
    s_and_b32 s18, s18, 7
    s_lshl_b32 s52, s18, 7
    s_add_u32 m0, s49, 0
    s_add_u32 s51, s52, 0
    buffer_load_dwordx4 v12, s[24:27], s51 offen lds
    buffer_load_dwordx4 v13, s[24:27], s51 offen offset:1024 lds
    buffer_load_dwordx4 v14, s[24:27], s51 offen offset:2048 lds
    buffer_load_dwordx4 v15, s[24:27], s51 offen offset:3072 lds
    s_add_u32 m0, s49, 13312
    s_add_u32 s51, s52, 1024
    buffer_load_dwordx4 v12, s[24:27], s51 offen lds
    buffer_load_dwordx4 v13, s[24:27], s51 offen offset:1024 lds
    buffer_load_dwordx4 v14, s[24:27], s51 offen offset:2048 lds
    buffer_load_dwordx4 v15, s[24:27], s51 offen offset:3072 lds
    s_add_u32 m0, s49, 26624
    s_add_u32 s51, s52, 32768
    buffer_load_dwordx4 v12, s[24:27], s51 offen lds
    buffer_load_dwordx4 v13, s[24:27], s51 offen offset:1024 lds
    buffer_load_dwordx4 v14, s[24:27], s51 offen offset:2048 lds
    buffer_load_dwordx4 v15, s[24:27], s51 offen offset:3072 lds
    s_mov_b32 s48, 6
    s_waitcnt vmcnt(12)
    s_barrier
    s_add_u32 m0, s49, 39936
    s_add_u32 s51, s52, 33792
    buffer_load_dwordx4 v12, s[24:27], s51 offen lds
    buffer_load_dwordx4 v13, s[24:27], s51 offen offset:1024 lds
    buffer_load_dwordx4 v14, s[24:27], s51 offen offset:2048 lds
    buffer_load_dwordx4 v15, s[24:27], s51 offen offset:3072 lds
    s_add_u32 s49, s49, 53248
    s_cmp_ge_u32 s49, 159744
    s_cselect_b32 s53, 159744, 0
    s_sub_u32 s49, s49, s53
    s_add_u32 s18, s18, 1
    s_and_b32 s18, s18, 7
K_xloop:
    s_lshl_b32 s52, s18, 7
    s_add_u32 m0, s49, 0
    s_add_u32 s51, s52, 0
    buffer_load_dwordx4 v12, s[24:27], s51 offen lds
    buffer_load_dwordx4 v13, s[24:27], s51 offen offset:1024 lds
    buffer_load_dwordx4 v14, s[24:27], s51 offen offset:2048 lds
    buffer_load_dwordx4 v15, s[24:27], s51 offen offset:3072 lds
    s_add_u32 m0, s49, 13312
    s_add_u32 s51, s52, 1024
    buffer_load_dwordx4 v12, s[24:27], s51 offen lds
    buffer_load_dwordx4 v13, s[24:27], s51 offen offset:1024 lds
    buffer_load_dwordx4 v14, s[24:27], s51 offen offset:2048 lds
    buffer_load_dwordx4 v15, s[24:27], s51 offen offset:3072 lds
    s_add_u32 m0, s49, 26624
    s_add_u32 s51, s52, 32768
    buffer_load_dwordx4 v12, s[24:27], s51 offen lds
    buffer_load_dwordx4 v13, s[24:27], s51 offen offset:1024 lds
    buffer_load_dwordx4 v14, s[24:27], s51 offen offset:2048 lds
    buffer_load_dwordx4 v15, s[24:27], s51 offen offset:3072 lds
    s_add_u32 m0, s49, 39936
    s_add_u32 s51, s52, 33792
    buffer_load_dwordx4 v12, s[24:27], s51 offen lds
    buffer_load_dwordx4 v13, s[24:27], s51 offen offset:1024 lds
    buffer_load_dwordx4 v14, s[24:27], s51 offen offset:2048 lds
    buffer_load_dwordx4 v15, s[24:27], s51 offen offset:3072 lds
    s_add_u32 s49, s49, 53248
    s_cmp_ge_u32 s49, 159744
    s_cselect_b32 s53, 159744, 0
    s_sub_u32 s49, s49, s53
    s_add_u32 s18, s18, 1
    s_and_b32 s18, s18, 7
    s_waitcnt vmcnt(16)
    s_barrier
    s_sub_u32 s48, s48, 1
    s_cmp_lg_u32 s48, 0
    s_cbranch_scc1 K_xloop
    s_mov_b32 s40, s6
    s_mov_b32 s41, s7
    s_mov_b32 s42, 16777216
    s_mov_b32 s43, 0x20000
    s_add_u32 s10, s6, 8585216
    s_addc_u32 s11, s7, 0
    s_load_dword s62, s[10:11], 0
    s_waitcnt vmcnt(0) lgkmcnt(0)
    s_barrier
    s_add_u32 s62, s62, 1
    v_add_u32 v42, 75776, v63
    v_lshrrev_b32 v47, 4, v1
    v_lshlrev_b32 v47, 12, v47
    v_and_b32 v44, 15, v1
    v_lshl_add_u32 v47, v44, 4, v47
    s_lshl_b32 s9, s16, 17
    s_lshl_b32 s45, s17, 8
    s_add_u32 s9, s9, s45
    s_add_u32 s9, s9, 6291456
    s_lshl_b32 s50, s16, 5
    s_add_u32 s50, s50, s17
    s_lshl_b32 s50, s50, 7
    s_add_u32 s50, s50, 8519680
    v_mov_b32 v45, s62
    v_mov_b32 v46, 0
    s_and_b32 s22, s17, 7
    s_sub_u32 s44, 7, s22
    s_cmp_lt_u32 s22, 4
    s_cselect_b32 s44, s22, s44
    s_lshl_b32 s44, s44, 9
    s_add_u32 s52, s44, 8519680
    s_add_u32 s44, s44, 512
    s_and_b32 s44, s44, 0x7ff
    s_add_u32 s51, s44, 8519680
    v_and_b32 v41, 15, v1
    v_lshlrev_b32 v41, 12, v41
    v_lshrrev_b32 v40, 4, v1
    v_lshl_add_u32 v40, v40, 7, v41
    s_barrier
    s_barrier
    ds_read_b128 v[64:67], v42 offset:0
    ds_read_b128 v[68:71], v42 offset:1024
    ds_read_b128 v[72:75], v42 offset:2048
    ds_read_b128 v[76:79], v42 offset:3072
    s_waitcnt lgkmcnt(3)
    buffer_store_dwordx4 v[64:67], v47, s[40:43], s9 offen sc1
    s_add_u32 s9, s9, 0x4000
    s_waitcnt lgkmcnt(2)
    buffer_store_dwordx4 v[68:71], v47, s[40:43], s9 offen sc1
    s_add_u32 s9, s9, 0x4000
    s_waitcnt lgkmcnt(1)
    buffer_store_dwordx4 v[72:75], v47, s[40:43], s9 offen sc1
    s_add_u32 s9, s9, 0x4000
    s_waitcnt lgkmcnt(0)
    buffer_store_dwordx4 v[76:79], v47, s[40:43], s9 offen sc1
    s_add_u32 s9, s9, 0x4000
    s_waitcnt vmcnt(0)
    s_mov_b64 exec, 1
    buffer_store_dword v45, v46, s[40:43], s50 offen sc1
    s_mov_b64 exec, -1
    v_mov_b32 v32, 163328
    s_mov_b32 s63, 0
K_p3aw:
    ds_read_b32 v34, v32
    s_add_u32 s63, s63, 1
    s_waitcnt lgkmcnt(0)
    v_cmp_eq_u32 vcc, 0, v34
    s_cbranch_vccz K_p3aw_ok
    s_sleep 1
    s_cmp_lt_u32 s63, 25600000
    s_cbranch_scc1 K_p3aw
K_p3aw_ok:
    s_mov_b32 s63, 0
K_p3a_s:
    buffer_load_dwordx2 v[28:29], v40, s[40:43], s52 offen sc1
    s_add_u32 s63, s63, 1
    s_waitcnt vmcnt(0)
    v_xor_b32 v28, s62, v28
    v_xor_b32 v29, s62, v29
    v_or_b32 v28, v28, v29
    v_cmp_ne_u32 vcc, 0, v28
    s_cbranch_vccz K_p3a_ok
    s_sleep 4
    s_cmp_lt_u32 s63, 400000
    s_cbranch_scc1 K_p3a_s
K_p3a_ok:
    v_mov_b32 v32, 163336
    v_mov_b32 v33, 1
    ds_write_b32 v32, v33
    s_endpgm
K_help:
    s_waitcnt lgkmcnt(0)
    s_mov_b32 s40, s6
    s_mov_b32 s41, s7
    s_mov_b32 s42, 16777216
    s_mov_b32 s43, 0x20000
    s_add_u32 s10, s6, 8585216
    s_addc_u32 s11, s7, 0
    s_load_dword s62, s[10:11], 0
    s_mov_b32 s96, s56
    s_mov_b32 s97, s57
    s_mov_b32 s98, 1409024
    s_mov_b32 s99, 0x20000
    v_and_b32 v42, 1, v1
    v_lshlrev_b32 v42, 7, v42
    s_lshl_b32 s54, s16, 12
    s_add_u32 s54, s54, 8388608
    s_getpc_b64 s[28:29]
K_pc:
    s_sub_u32 s28, s28, K_pc-K_start
    s_subb_u32 s29, s29, 0
    s_mov_b32 s30, K_stop-K_start
    s_mov_b32 s31, 0x20000
    s_and_b32 s44, s17, 3
    s_mul_i32 s44, s44, 5120
    v_min_u32 v43, 39, v1
    v_lshlrev_b32 v43, 7, v43
    buffer_load_dword v29, v43, s[28:31], s44 offen
    buffer_load_dword v28, v42, s[40:43], s54 offen sc1
    v_and_b32 v3, 31, v1
    v_lshrrev_b32 v4, 5, v1
    v_lshrrev_b32 v42, 4, v1
    v_and_b32 v42, 1, v42
    v_lshrrev_b32 v43, 2, v1
    v_and_b32 v43, 3, v43
    v_lshl_add_u32 v44, v43, 1, v42
    v_mul_u32_u24 v45, 26624, v4
    v_lshl_add_u32 v45, v42, 10, v45
    v_lshl_add_u32 v45, v43, 8, v45
    v_and_b32 v43, 3, v1
    v_lshl_add_u32 v45, v43, 3, v45
    v_add_u32 v45, 5120, v45
    s_lshl_b32 s44, s8, 12
    v_add_u32 v45, s44, v45
    v_xor_b32 v43, 0, v44
    v_lshl_add_u32 v12, v43, 5, v45
    v_xor_b32 v43, 1, v44
    v_lshl_add_u32 v13, v43, 5, v45
    v_xor_b32 v43, 2, v44
    v_lshl_add_u32 v14, v43, 5, v45
    v_xor_b32 v43, 3, v44
    v_lshl_add_u32 v15, v43, 5, v45
    v_xor_b32 v43, 4, v44
    v_lshl_add_u32 v16, v43, 5, v45
    v_xor_b32 v43, 5, v44
    v_lshl_add_u32 v17, v43, 5, v45
    v_mov_b32 v32, 0
    v_mov_b32 v33, 0
    v_mov_b32 v34, 0
    v_mov_b32 v35, 0
    v_add_u32 v42, 162816, v63
    ds_write_b128 v42, v[32:35]
    s_lshr_b32 s44, s2, 3
    s_lshl_b32 s44, s44, 2
    v_lshrrev_b32 v26, 2, v1
    v_mul_u32_u24 v26, 688, v26
    v_and_b32 v43, 3, v1
    v_add3_u32 v26, v26, v43, s44
    v_lshlrev_b32 v26, 10, v26
    v_add_u32 v26, 384, v26
    v_cmp_gt_u32 vcc, 8, v1
    v_mov_b32 v43, 1073741824
    s_nop 0
    v_cndmask_b32 v26, v43, v26, vcc
    s_mul_i32 s44, s2, 5504
    v_min_u32 v43, 42, v1
    v_lshlrev_b32 v43, 7, v43
    buffer_load_dword v31, v43, s[96:99], s44 offen
    s_waitcnt lgkmcnt(0)
    s_add_u32 s62, s62, 1
    v_add_u32 v42, 102400, v63
    v_lshrrev_b32 v47, 4, v1
    v_lshlrev_b32 v47, 12, v47
    v_and_b32 v44, 15, v1
    v_lshl_add_u32 v47, v44, 4, v47
    s_lshl_b32 s9, s16, 17
    s_lshl_b32 s45, s17, 8
    s_add_u32 s9, s9, s45
    s_add_u32 s9, s9, 6356992
    s_lshl_b32 s50, s16, 5
    s_add_u32 s50, s50, s17
    s_lshl_b32 s50, s50, 7
    s_add_u32 s50, s50, 8519684
    v_mov_b32 v45, s62
    v_mov_b32 v46, 0
    buffer_load_dword v36, v46, s[40:43], s9 offen sc1
    s_barrier
    ds_read_b64_tr_b16 v[64:65], v12 offset:0
    ds_read_b64_tr_b16 v[66:67], v12 offset:13312
    ds_read_b64_tr_b16 v[68:69], v12 offset:2048
    ds_read_b64_tr_b16 v[70:71], v12 offset:15360
    ds_read_b64_tr_b16 v[72:73], v13 offset:0
    ds_read_b64_tr_b16 v[74:75], v13 offset:13312
    ds_read_b64_tr_b16 v[76:77], v13 offset:2048
    ds_read_b64_tr_b16 v[78:79], v13 offset:15360
    ds_read_b64_tr_b16 v[80:81], v14 offset:0
    ds_read_b64_tr_b16 v[82:83], v14 offset:13312
    ds_read_b64_tr_b16 v[84:85], v14 offset:2048
    ds_read_b64_tr_b16 v[86:87], v14 offset:15360
    ds_read_b64_tr_b16 v[88:89], v15 offset:0
    ds_read_b64_tr_b16 v[90:91], v15 offset:13312
    ds_read_b64_tr_b16 v[92:93], v15 offset:2048
    ds_read_b64_tr_b16 v[94:95], v15 offset:15360
    ds_read_b64_tr_b16 v[96:97], v16 offset:0
    ds_read_b64_tr_b16 v[98:99], v16 offset:13312
    ds_read_b64_tr_b16 v[100:101], v16 offset:2048
    ds_read_b64_tr_b16 v[102:103], v16 offset:15360
    ds_read_b64_tr_b16 v[104:105], v17 offset:0
    ds_read_b64_tr_b16 v[106:107], v17 offset:13312
    ds_read_b64_tr_b16 v[108:109], v17 offset:2048
    ds_read_b64_tr_b16 v[110:111], v17 offset:15360
    s_waitcnt lgkmcnt(0)
    v_lshlrev_b32 v120, 16, v64
    v_and_b32 v121, 0xffff0000, v64
    v_add_f32 v112, v120, v121
    v_lshlrev_b32 v120, 16, v65
    v_and_b32 v121, 0xffff0000, v65
    v_add_f32 v112, v112, v120
    v_add_f32 v112, v112, v121
    v_lshlrev_b32 v120, 16, v66
    v_and_b32 v121, 0xffff0000, v66
    v_add_f32 v112, v112, v120
    v_add_f32 v112, v112, v121
    v_lshlrev_b32 v120, 16, v67
    v_and_b32 v121, 0xffff0000, v67
    v_add_f32 v112, v112, v120
    v_add_f32 v112, v112, v121
    v_lshlrev_b32 v120, 16, v68
    v_and_b32 v121, 0xffff0000, v68
    v_add_f32 v112, v112, v120
    v_add_f32 v112, v112, v121
    v_lshlrev_b32 v120, 16, v69
    v_and_b32 v121, 0xffff0000, v69
    v_add_f32 v112, v112, v120
    v_add_f32 v112, v112, v121
    v_lshlrev_b32 v120, 16, v70
    v_and_b32 v121, 0xffff0000, v70
    v_add_f32 v112, v112, v120
    v_add_f32 v112, v112, v121
    v_lshlrev_b32 v120, 16, v71
    v_and_b32 v121, 0xffff0000, v71
    v_add_f32 v112, v112, v120
    v_add_f32 v112, v112, v121
    v_lshlrev_b32 v120, 16, v72
    v_and_b32 v121, 0xffff0000, v72
    v_add_f32 v113, v120, v121
    v_lshlrev_b32 v120, 16, v73
    v_and_b32 v121, 0xffff0000, v73
    v_add_f32 v113, v113, v120
    v_add_f32 v113, v113, v121
    v_lshlrev_b32 v120, 16, v74
    v_and_b32 v121, 0xffff0000, v74
    v_add_f32 v113, v113, v120
    v_add_f32 v113, v113, v121
    v_lshlrev_b32 v120, 16, v75
    v_and_b32 v121, 0xffff0000, v75
    v_add_f32 v113, v113, v120
    v_add_f32 v113, v113, v121
    v_lshlrev_b32 v120, 16, v76
    v_and_b32 v121, 0xffff0000, v76
    v_add_f32 v113, v113, v120
    v_add_f32 v113, v113, v121
    v_lshlrev_b32 v120, 16, v77
    v_and_b32 v121, 0xffff0000, v77
    v_add_f32 v113, v113, v120
    v_add_f32 v113, v113, v121
    v_lshlrev_b32 v120, 16, v78
    v_and_b32 v121, 0xffff0000, v78
    v_add_f32 v113, v113, v120
    v_add_f32 v113, v113, v121
    v_lshlrev_b32 v120, 16, v79
    v_and_b32 v121, 0xffff0000, v79
    v_add_f32 v113, v113, v120
    v_add_f32 v113, v113, v121
    v_lshlrev_b32 v120, 16, v80
    v_and_b32 v121, 0xffff0000, v80
    v_add_f32 v114, v120, v121
    v_lshlrev_b32 v120, 16, v81
    v_and_b32 v121, 0xffff0000, v81
    v_add_f32 v114, v114, v120
    v_add_f32 v114, v114, v121
    v_lshlrev_b32 v120, 16, v82
    v_and_b32 v121, 0xffff0000, v82
    v_add_f32 v114, v114, v120
    v_add_f32 v114, v114, v121
    v_lshlrev_b32 v120, 16, v83
    v_and_b32 v121, 0xffff0000, v83
    v_add_f32 v114, v114, v120
    v_add_f32 v114, v114, v121
    v_lshlrev_b32 v120, 16, v84
    v_and_b32 v121, 0xffff0000, v84
    v_add_f32 v114, v114, v120
    v_add_f32 v114, v114, v121
    v_lshlrev_b32 v120, 16, v85
    v_and_b32 v121, 0xffff0000, v85
    v_add_f32 v114, v114, v120
    v_add_f32 v114, v114, v121
    v_lshlrev_b32 v120, 16, v86
    v_and_b32 v121, 0xffff0000, v86
    v_add_f32 v114, v114, v120
    v_add_f32 v114, v114, v121
    v_lshlrev_b32 v120, 16, v87
    v_and_b32 v121, 0xffff0000, v87
    v_add_f32 v114, v114, v120
    v_add_f32 v114, v114, v121
    s_barrier
    v_lshlrev_b32 v120, 16, v88
    v_and_b32 v121, 0xffff0000, v88
    v_add_f32 v115, v120, v121
    v_lshlrev_b32 v120, 16, v89
    v_and_b32 v121, 0xffff0000, v89
    v_add_f32 v115, v115, v120
    v_add_f32 v115, v115, v121
    v_lshlrev_b32 v120, 16, v90
    v_and_b32 v121, 0xffff0000, v90
    v_add_f32 v115, v115, v120
    v_add_f32 v115, v115, v121
    v_lshlrev_b32 v120, 16, v91
    v_and_b32 v121, 0xffff0000, v91
    v_add_f32 v115, v115, v120
    v_add_f32 v115, v115, v121
    v_lshlrev_b32 v120, 16, v92
    v_and_b32 v121, 0xffff0000, v92
    v_add_f32 v115, v115, v120
    v_add_f32 v115, v115, v121
    v_lshlrev_b32 v120, 16, v93
    v_and_b32 v121, 0xffff0000, v93
    v_add_f32 v115, v115, v120
    v_add_f32 v115, v115, v121
    v_lshlrev_b32 v120, 16, v94
    v_and_b32 v121, 0xffff0000, v94
    v_add_f32 v115, v115, v120
    v_add_f32 v115, v115, v121
    v_lshlrev_b32 v120, 16, v95
    v_and_b32 v121, 0xffff0000, v95
    v_add_f32 v115, v115, v120
    v_add_f32 v115, v115, v121
    v_lshlrev_b32 v120, 16, v96
    v_and_b32 v121, 0xffff0000, v96
    v_add_f32 v116, v120, v121
    v_lshlrev_b32 v120, 16, v97
    v_and_b32 v121, 0xffff0000, v97
    v_add_f32 v116, v116, v120
    v_add_f32 v116, v116, v121
    v_lshlrev_b32 v120, 16, v98
    v_and_b32 v121, 0xffff0000, v98
    v_add_f32 v116, v116, v120
    v_add_f32 v116, v116, v121
    v_lshlrev_b32 v120, 16, v99
    v_and_b32 v121, 0xffff0000, v99
    v_add_f32 v116, v116, v120
    v_add_f32 v116, v116, v121
    v_lshlrev_b32 v120, 16, v100
    v_and_b32 v121, 0xffff0000, v100
    v_add_f32 v116, v116, v120
    v_add_f32 v116, v116, v121
    v_lshlrev_b32 v120, 16, v101
    v_and_b32 v121, 0xffff0000, v101
    v_add_f32 v116, v116, v120
    v_add_f32 v116, v116, v121
    v_lshlrev_b32 v120, 16, v102
    v_and_b32 v121, 0xffff0000, v102
    v_add_f32 v116, v116, v120
    v_add_f32 v116, v116, v121
    v_lshlrev_b32 v120, 16, v103
    v_and_b32 v121, 0xffff0000, v103
    v_add_f32 v116, v116, v120
    v_add_f32 v116, v116, v121
    v_lshlrev_b32 v120, 16, v104
    v_and_b32 v121, 0xffff0000, v104
    v_add_f32 v117, v120, v121
    v_lshlrev_b32 v120, 16, v105
    v_and_b32 v121, 0xffff0000, v105
    v_add_f32 v117, v117, v120
    v_add_f32 v117, v117, v121
    v_lshlrev_b32 v120, 16, v106
    v_and_b32 v121, 0xffff0000, v106
    v_add_f32 v117, v117, v120
    v_add_f32 v117, v117, v121
    v_lshlrev_b32 v120, 16, v107
    v_and_b32 v121, 0xffff0000, v107
    v_add_f32 v117, v117, v120
    v_add_f32 v117, v117, v121
    v_lshlrev_b32 v120, 16, v108
    v_and_b32 v121, 0xffff0000, v108
    v_add_f32 v117, v117, v120
    v_add_f32 v117, v117, v121
    v_lshlrev_b32 v120, 16, v109
    v_and_b32 v121, 0xffff0000, v109
    v_add_f32 v117, v117, v120
    v_add_f32 v117, v117, v121
    v_lshlrev_b32 v120, 16, v110
    v_and_b32 v121, 0xffff0000, v110
    v_add_f32 v117, v117, v120
    v_add_f32 v117, v117, v121
    v_lshlrev_b32 v120, 16, v111
    v_and_b32 v121, 0xffff0000, v111
    v_add_f32 v117, v117, v120
    v_add_f32 v117, v117, v121
    v_permlane32_swap_b32 v112, v115
    v_permlane32_swap_b32 v113, v116
    v_permlane32_swap_b32 v114, v117
    v_add_f32 v112, v112, v115
    v_add_f32 v113, v113, v116
    v_add_f32 v114, v114, v117
    v_mov_b32 v115, s62
    s_lshl_b32 s44, s16, 4
    s_add_u32 s44, s44, s17
    s_lshl_b32 s44, s44, 10
    s_add_u32 s44, s44, 8912896
    buffer_store_dwordx4 v[112:115], v63, s[40:43], s44 offen sc1
    s_mov_b32 s44, 0
    buffer_load_dword v30, v26, s[96:99], s44 offen
    s_lshl_b32 s48, s16, 11
    s_add_u32 s48, s48, 8650752
    s_lshl_b32 s49, s17, 10
    s_add_u32 s49, s49, 8912896
    s_barrier
    s_mov_b32 s44, 131072
    buffer_load_dword v30, v26, s[96:99], s44 offen
    s_mov_b32 s44, 262144
    buffer_load_dword v30, v26, s[96:99], s44 offen
    s_barrier
    buffer_load_dwordx4 v[48:51], v63, s[40:43], s48 offen offset:0 sc1
    buffer_load_dwordx4 v[52:55], v63, s[40:43], s48 offen offset:1024 sc1
    s_add_u32 s44, s49, 0
    buffer_load_dwordx4 v[128:131], v63, s[40:43], s44 offen sc1
    s_add_u32 s44, s49, 16384
    buffer_load_dwordx4 v[132:135], v63, s[40:43], s44 offen sc1
    s_add_u32 s44, s49, 32768
    buffer_load_dwordx4 v[136:139], v63, s[40:43], s44 offen sc1
    s_add_u32 s44, s49, 49152
    buffer_load_dwordx4 v[140:143], v63, s[40:43], s44 offen sc1
    s_add_u32 s44, s49, 65536
    buffer_load_dwordx4 v[144:147], v63, s[40:43], s44 offen sc1
    s_mov_b32 s44, 393216
    buffer_load_dword v30, v26, s[96:99], s44 offen
    s_barrier
    s_add_u32 s44, s49, 81920
    buffer_load_dwordx4 v[148:151], v63, s[40:43], s44 offen sc1
    s_add_u32 s44, s49, 98304
    buffer_load_dwordx4 v[152:155], v63, s[40:43], s44 offen sc1
    s_add_u32 s44, s49, 114688
    buffer_load_dwordx4 v[156:159], v63, s[40:43], s44 offen sc1
    s_add_u32 s44, s49, 131072
    buffer_load_dwordx4 v[160:163], v63, s[40:43], s44 offen sc1
    s_add_u32 s44, s49, 147456
    buffer_load_dwordx4 v[164:167], v63, s[40:43], s44 offen sc1
    s_add_u32 s44, s49, 163840
    buffer_load_dwordx4 v[168:171], v63, s[40:43], s44 offen sc1
    s_mov_b32 s44, 524288
    buffer_load_dword v30, v26, s[96:99], s44 offen
    s_barrier
    s_add_u32 s44, s49, 180224
    buffer_load_dwordx4 v[172:175], v63, s[40:43], s44 offen sc1
    s_add_u32 s44, s49, 196608
    buffer_load_dwordx4 v[176:179], v63, s[40:43], s44 offen sc1
    s_add_u32 s44, s49, 212992
    buffer_load_dwordx4 v[180:183], v63, s[40:43], s44 offen sc1
    s_add_u32 s44, s49, 229376
    buffer_load_dwordx4 v[184:187], v63, s[40:43], s44 offen sc1
    s_add_u32 s44, s49, 245760
    buffer_load_dwordx4 v[188:191], v63, s[40:43], s44 offen sc1
    s_mov_b32 s44, 655360
    buffer_load_dword v30, v26, s[96:99], s44 offen
    s_barrier
    s_mov_b32 s63, 0
K_chk:
    s_waitcnt vmcnt(0)
    v_xor_b32 v56, s62, v50
    v_xor_b32 v57, s62, v54
    v_or_b32 v56, v56, v57
    v_xor_b32 v57, s62, v131
    v_or_b32 v56, v56, v57
    v_xor_b32 v57, s62, v135
    v_or_b32 v56, v56, v57
    v_xor_b32 v57, s62, v139
    v_or_b32 v56, v56, v57
    v_xor_b32 v57, s62, v143
    v_or_b32 v56, v56, v57
    v_xor_b32 v57, s62, v147
    v_or_b32 v56, v56, v57
    v_xor_b32 v57, s62, v151
    v_or_b32 v56, v56, v57
    v_xor_b32 v57, s62, v155
    v_or_b32 v56, v56, v57
    v_xor_b32 v57, s62, v159
    v_or_b32 v56, v56, v57
    v_xor_b32 v57, s62, v163
    v_or_b32 v56, v56, v57
    v_xor_b32 v57, s62, v167
    v_or_b32 v56, v56, v57
    v_xor_b32 v57, s62, v171
    v_or_b32 v56, v56, v57
    v_xor_b32 v57, s62, v175
    v_or_b32 v56, v56, v57
    v_xor_b32 v57, s62, v179
    v_or_b32 v56, v56, v57
    v_xor_b32 v57, s62, v183
    v_or_b32 v56, v56, v57
    v_xor_b32 v57, s62, v187
    v_or_b32 v56, v56, v57
    v_xor_b32 v57, s62, v191
    v_or_b32 v56, v56, v57
    v_cmp_ne_u32 vcc, 0, v56
    s_cbranch_vccz K_cok
    s_sleep 4
    buffer_load_dwordx4 v[48:51], v63, s[40:43], s48 offen offset:0 sc1
    buffer_load_dwordx4 v[52:55], v63, s[40:43], s48 offen offset:1024 sc1
    s_add_u32 s44, s49, 0
    buffer_load_dwordx4 v[128:131], v63, s[40:43], s44 offen sc1
    s_add_u32 s44, s49, 16384
    buffer_load_dwordx4 v[132:135], v63, s[40:43], s44 offen sc1
    s_add_u32 s44, s49, 32768
    buffer_load_dwordx4 v[136:139], v63, s[40:43], s44 offen sc1
    s_add_u32 s44, s49, 49152
    buffer_load_dwordx4 v[140:143], v63, s[40:43], s44 offen sc1
    s_add_u32 s44, s49, 65536
    buffer_load_dwordx4 v[144:147], v63, s[40:43], s44 offen sc1
    s_add_u32 s44, s49, 81920
    buffer_load_dwordx4 v[148:151], v63, s[40:43], s44 offen sc1
    s_add_u32 s44, s49, 98304
    buffer_load_dwordx4 v[152:155], v63, s[40:43], s44 offen sc1
    s_add_u32 s44, s49, 114688
    buffer_load_dwordx4 v[156:159], v63, s[40:43], s44 offen sc1
    s_add_u32 s44, s49, 131072
    buffer_load_dwordx4 v[160:163], v63, s[40:43], s44 offen sc1
    s_add_u32 s44, s49, 147456
    buffer_load_dwordx4 v[164:167], v63, s[40:43], s44 offen sc1
    s_add_u32 s44, s49, 163840
    buffer_load_dwordx4 v[168:171], v63, s[40:43], s44 offen sc1
    s_add_u32 s44, s49, 180224
    buffer_load_dwordx4 v[172:175], v63, s[40:43], s44 offen sc1
    s_add_u32 s44, s49, 196608
    buffer_load_dwordx4 v[176:179], v63, s[40:43], s44 offen sc1
    s_add_u32 s44, s49, 212992
    buffer_load_dwordx4 v[180:183], v63, s[40:43], s44 offen sc1
    s_add_u32 s44, s49, 229376
    buffer_load_dwordx4 v[184:187], v63, s[40:43], s44 offen sc1
    s_add_u32 s44, s49, 245760
    buffer_load_dwordx4 v[188:191], v63, s[40:43], s44 offen sc1
    s_add_u32 s63, s63, 1
    s_cmp_lt_u32 s63, 400000
    s_cbranch_scc1 K_chk
    s_waitcnt vmcnt(0)
K_cok:
    v_lshlrev_b32 v60, 3, v1
    v_add_u32 v60, 161280, v60
    v_lshlrev_b32 v61, 2, v1
    v_add_u32 v61, 162304, v61
    v_cvt_pk_bf16_f32 v56, -v48, -v48
    v_and_b32 v57, 0xffff0000, v56
    v_sub_f32 v48, -v48, v57
    v_cvt_pk_bf16_f32 v56, v57, v48
    v_lshrrev_b32 v57, 16, v57
    ds_write_b64 v60, v[56:57] offset:0
    ds_write_b32 v61, v49 offset:0
    v_cvt_pk_bf16_f32 v58, -v52, -v52
    v_and_b32 v59, 0xffff0000, v58
    v_sub_f32 v52, -v52, v59
    v_cvt_pk_bf16_f32 v58, v59, v52
    v_lshrrev_b32 v59, 16, v59
    ds_write_b64 v60, v[58:59] offset:512
    ds_write_b32 v61, v53 offset:256
    v_add_f32 v128, v128, v132
    v_add_f32 v129, v129, v133
    v_add_f32 v130, v130, v134
    v_add_f32 v128, v128, v136
    v_add_f32 v129, v129, v137
    v_add_f32 v130, v130, v138
    v_add_f32 v128, v128, v140
    v_add_f32 v129, v129, v141
    v_add_f32 v130, v130, v142
    v_add_f32 v128, v128, v144
    v_add_f32 v129, v129, v145
    v_add_f32 v130, v130, v146
    v_add_f32 v128, v128, v148
    v_add_f32 v129, v129, v149
    v_add_f32 v130, v130, v150
    s_barrier
    v_add_f32 v128, v128, v152
    v_add_f32 v129, v129, v153
    v_add_f32 v130, v130, v154
    v_add_f32 v128, v128, v156
    v_add_f32 v129, v129, v157
    v_add_f32 v130, v130, v158
    v_add_f32 v128, v128, v160
    v_add_f32 v129, v129, v161
    v_add_f32 v130, v130, v162
    v_add_f32 v128, v128, v164
    v_add_f32 v129, v129, v165
    v_add_f32 v130, v130, v166
    v_add_f32 v128, v128, v168
    v_add_f32 v129, v129, v169
    v_add_f32 v130, v130, v170
    v_add_f32 v128, v128, v172
    v_add_f32 v129, v129, v173
    v_add_f32 v130, v130, v174
    v_add_f32 v128, v128, v176
    v_add_f32 v129, v129, v177
    v_add_f32 v130, v130, v178
    v_add_f32 v128, v128, v180
    v_add_f32 v129, v129, v181
    v_add_f32 v130, v130, v182
    v_add_f32 v128, v128, v184
    v_add_f32 v129, v129, v185
    v_add_f32 v130, v130, v186
    v_add_f32 v128, v128, v188
    v_add_f32 v129, v129, v189
    v_add_f32 v130, v130, v190
    v_mul_u32_u24 v60, 768, v4
    v_lshl_add_u32 v60, v3, 3, v60
    v_add_u32 v60, 159744, v60
    v_cvt_pk_bf16_f32 v132, v128, v128
    v_and_b32 v133, 0xffff0000, v132
    v_sub_f32 v133, v128, v133
    v_cvt_pk_bf16_f32 v133, v133, v133
    ds_write_b64 v60, v[132:133] offset:0
    v_cvt_pk_bf16_f32 v134, v129, v129
    v_and_b32 v135, 0xffff0000, v134
    v_sub_f32 v135, v129, v135
    v_cvt_pk_bf16_f32 v135, v135, v135
    ds_write_b64 v60, v[134:135] offset:256
    v_cvt_pk_bf16_f32 v136, v130, v130
    v_and_b32 v137, 0xffff0000, v136
    v_sub_f32 v137, v130, v137
    v_cvt_pk_bf16_f32 v137, v137, v137
    ds_write_b64 v60, v[136:137] offset:512
    s_and_b32 s22, s17, 7
    s_sub_u32 s44, 7, s22
    s_cmp_lt_u32 s22, 4
    s_cselect_b32 s44, s22, s44
    s_lshl_b32 s44, s44, 9
    s_add_u32 s52, s44, 8519680
    s_add_u32 s44, s44, 512
    s_and_b32 s44, s44, 0x7ff
    s_add_u32 s51, s44, 8519680
    v_and_b32 v41, 15, v1
    v_lshlrev_b32 v41, 12, v41
    v_lshrrev_b32 v40, 4, v1
    v_lshl_add_u32 v40, v40, 7, v41
    s_waitcnt lgkmcnt(0)
    s_barrier
    s_barrier
    ds_read_b128 v[64:67], v42 offset:0
    ds_read_b128 v[68:71], v42 offset:1024
    ds_read_b128 v[72:75], v42 offset:2048
    ds_read_b128 v[76:79], v42 offset:3072
    s_waitcnt lgkmcnt(3)
    buffer_store_dwordx4 v[64:67], v47, s[40:43], s9 offen sc1
    s_add_u32 s9, s9, 0x4000
    s_waitcnt lgkmcnt(2)
    buffer_store_dwordx4 v[68:71], v47, s[40:43], s9 offen sc1
    s_add_u32 s9, s9, 0x4000
    s_waitcnt lgkmcnt(1)
    buffer_store_dwordx4 v[72:75], v47, s[40:43], s9 offen sc1
    s_add_u32 s9, s9, 0x4000
    s_waitcnt lgkmcnt(0)
    buffer_store_dwordx4 v[76:79], v47, s[40:43], s9 offen sc1
    s_add_u32 s9, s9, 0x4000
    s_waitcnt vmcnt(0)
    s_mov_b64 exec, 1
    buffer_store_dword v45, v46, s[40:43], s50 offen sc1
    s_mov_b64 exec, -1
    v_mov_b32 v32, 163328
    s_mov_b32 s63, 0
K_p3bw:
    ds_read_b32 v34, v32
    s_add_u32 s63, s63, 1
    s_waitcnt lgkmcnt(0)
    v_cmp_eq_u32 vcc, 0, v34
    s_cbranch_vccz K_p3bw_ok
    s_sleep 1
    s_cmp_lt_u32 s63, 25600000
    s_cbranch_scc1 K_p3bw
K_p3bw_ok:
    v_and_b32 v44, 3, v1
    v_lshlrev_b32 v44, 2, v44
    s_lshl_b32 s44, s17, 4
    v_add_u32 v44, s44, v44
    s_add_u32 s44, s54, 65536
    s_mov_b64 exec, 15
    buffer_store_dword v45, v44, s[40:43], s44 offen sc1
    s_mov_b64 exec, -1
    s_mov_b32 s63, 0
K_p3b_s:
    buffer_load_dwordx2 v[28:29], v41, s[40:43], s51 offen sc1
    s_add_u32 s63, s63, 1
    s_waitcnt vmcnt(0)
    v_xor_b32 v28, s62, v28
    v_xor_b32 v29, s62, v29
    v_or_b32 v28, v28, v29
    v_cmp_ne_u32 vcc, 0, v28
    s_cbranch_vccz K_p3b_ok
    s_sleep 4
    s_cmp_lt_u32 s63, 400000
    s_cbranch_scc1 K_p3b_s
K_p3b_ok:
    v_mov_b32 v32, 163340
    v_mov_b32 v33, 1
    ds_write_b32 v32, v33
    s_cmp_eq_u32 s2, 0
    s_cbranch_scc0 K_end
    s_mov_b32 s50, 8519680
    s_mov_b32 s63, 0
K_pe0_s:
    buffer_load_dwordx2 v[28:29], v40, s[40:43], s50 offen sc1
    s_add_u32 s63, s63, 1
    s_waitcnt vmcnt(0)
    v_xor_b32 v28, s62, v28
    v_xor_b32 v29, s62, v29
    v_or_b32 v28, v28, v29
    v_cmp_ne_u32 vcc, 0, v28
    s_cbranch_vccz K_pe0_ok
    s_sleep 4
    s_cmp_lt_u32 s63, 400000
    s_cbranch_scc1 K_pe0_s
K_pe0_ok:
    s_mov_b32 s50, 8520192
    s_mov_b32 s63, 0
K_pe1_s:
    buffer_load_dwordx2 v[28:29], v40, s[40:43], s50 offen sc1
    s_add_u32 s63, s63, 1
    s_waitcnt vmcnt(0)
    v_xor_b32 v28, s62, v28
    v_xor_b32 v29, s62, v29
    v_or_b32 v28, v28, v29
    v_cmp_ne_u32 vcc, 0, v28
    s_cbranch_vccz K_pe1_ok
    s_sleep 4
    s_cmp_lt_u32 s63, 400000
    s_cbranch_scc1 K_pe1_s
K_pe1_ok:
    s_mov_b32 s50, 8520704
    s_mov_b32 s63, 0
K_pe2_s:
    buffer_load_dwordx2 v[28:29], v40, s[40:43], s50 offen sc1
    s_add_u32 s63, s63, 1
    s_waitcnt vmcnt(0)
    v_xor_b32 v28, s62, v28
    v_xor_b32 v29, s62, v29
    v_or_b32 v28, v28, v29
    v_cmp_ne_u32 vcc, 0, v28
    s_cbranch_vccz K_pe2_ok
    s_sleep 4
    s_cmp_lt_u32 s63, 400000
    s_cbranch_scc1 K_pe2_s
K_pe2_ok:
    s_mov_b32 s50, 8521216
    s_mov_b32 s63, 0
K_pe3_s:
    buffer_load_dwordx2 v[28:29], v40, s[40:43], s50 offen sc1
    s_add_u32 s63, s63, 1
    s_waitcnt vmcnt(0)
    v_xor_b32 v28, s62, v28
    v_xor_b32 v29, s62, v29
    v_or_b32 v28, v28, v29
    v_cmp_ne_u32 vcc, 0, v28
    s_cbranch_vccz K_pe3_ok
    s_sleep 4
    s_cmp_lt_u32 s63, 400000
    s_cbranch_scc1 K_pe3_s
K_pe3_ok:
    s_mov_b32 s50, 8585216
    s_mov_b64 exec, 1
    buffer_store_dword v45, v46, s[40:43], s50 offen sc1
    s_endpgm
K_compute:
    s_lshr_b32 s48, s17, 2
    s_and_b32 s44, s48, 1
    s_lshr_b32 s45, s48, 1
    s_lshl_b32 s45, s45, 5
    s_add_u32 s44, s44, s45
    s_lshl_b32 s47, s16, 1
    s_add_u32 s47, s47, s44
    s_and_b32 s44, s17, 3
    s_lshl_b32 s44, s44, 3
    s_lshl_b32 s45, s46, 1
    s_add_u32 s44, s44, s45
    s_lshl_b32 s44, s44, 6
    s_add_u32 s50, s47, s44
    s_lshl_b32 s50, s50, 10
    s_add_u32 s51, s50, 65536
    s_waitcnt lgkmcnt(0)
    s_mov_b32 s24, s4
    s_mov_b32 s25, s5
    s_mov_b32 s26, 2097152
    s_mov_b32 s27, 0x20000
    buffer_load_dwordx4 v[76:79], v63, s[24:27], s50 offen
    buffer_load_dwordx4 v[80:83], v63, s[24:27], s51 offen
    s_add_u32 s28, s6, 8585216
    s_addc_u32 s29, s7, 0
    s_load_dword s62, s[28:29], 0
    s_and_b32 s22, s17, 7
    s_lshr_b32 s9, s17, 3
    s_lshl_b32 s44, s16, 1
    s_add_u32 s23, s9, s44
    s_lshr_b32 s48, s46, 1
    s_and_b32 s49, s46, 1
    s_lshl_b32 s52, s49, 5
    s_add_u32 s52, s52, s23
    s_lshl_b32 s44, s22, 6
    s_lshl_b32 s45, s48, 5
    s_add_u32 s53, s44, s45
    v_lshrrev_b32 v7, 2, v1
    v_lshrrev_b32 v8, 2, v7
    v_xor_b32 v8, v8, v1
    v_and_b32 v8, 3, v8
    v_lshlrev_b32 v7, 16, v7
    v_lshl_add_u32 v7, v8, 4, v7
    s_lshl_b32 s44, s52, 10
    s_lshl_b32 s45, s53, 1
    s_add_u32 s44, s44, s45
    v_add_u32 v248, s44, v7
    v_add_u32 v249, 0x100000, v248
    buffer_load_dwordx4 v[84:87], v248, s[24:27], 0 offen
    buffer_load_dwordx4 v[88:91], v249, s[24:27], 0 offen
    s_mov_b32 s40, s6
    s_mov_b32 s41, s7
    s_mov_b32 s42, 16777216
    s_mov_b32 s43, 0x20000
    s_mov_b32 s32, s58
    s_mov_b32 s33, s59
    s_mov_b32 s34, 2097152
    s_mov_b32 s35, 0x20000
    s_mov_b32 s61, 53248
    s_min_u32 s44, s17, 6
    s_mul_i32 s20, s17, 5
    s_add_u32 s20, s20, s44
    s_cmp_lt_u32 s17, 6
    s_cselect_b32 s21, 6, 5
    s_and_b32 s44, s46, 1
    s_lshr_b32 s45, s46, 1
    s_lshl_b32 s45, s45, 5
    s_add_u32 s44, s44, s45
    s_lshl_b32 s47, s16, 1
    s_add_u32 s47, s47, s44
    s_mul_i32 s101, s47, 86
    s_add_u32 s101, s101, s20
    s_mul_i32 s44, s49, 3
    s_add_u32 s101, s101, s44
    s_lshl_b32 s101, s101, 10
    s_mov_b64 exec, 1
    buffer_load_dword v253, v248, s[32:35], 0 offen sc1
    buffer_load_dword v255, v63, s[40:43], s101 offen sc1
    s_mov_b32 exec_lo, 0
    s_mov_b32 exec_hi, 0x80000000
    buffer_load_dword v254, v249, s[32:35], 0 offen sc1
    s_mov_b64 exec, -1
    v_and_b32 v3, 31, v1
    v_lshrrev_b32 v4, 5, v1
    v_lshrrev_b32 v5, 1, v3
    v_and_b32 v5, 7, v5
    v_xor_b32 v5, v5, v4
    v_lshlrev_b32 v5, 4, v5
    v_lshl_add_u32 v6, v3, 7, v5
    s_mul_i32 s54, s46, 13312
    s_xor_b32 s44, s46, 1
    s_mul_i32 s44, s44, 13312
    v_add_u32 v5, s44, v6
    v_add_u32 v6, s54, v6
    v_lshrrev_b32 v7, 4, v1
    v_and_b32 v7, 1, v7
    v_lshrrev_b32 v8, 2, v1
    v_and_b32 v8, 3, v8
    v_lshl_add_u32 v9, v8, 1, v7
    v_mul_u32_u24 v10, 26624, v4
    v_lshl_add_u32 v10, v7, 10, v10
    v_lshl_add_u32 v10, v8, 8, v10
    v_and_b32 v8, 3, v1
    v_lshl_add_u32 v10, v8, 3, v10
    v_add_u32 v10, 5120, v10
    v_xor_b32 v48, 0, v6
    v_xor_b32 v56, 0, v5
    v_xor_b32 v49, 32, v6
    v_xor_b32 v57, 32, v5
    v_xor_b32 v50, 64, v6
    v_xor_b32 v58, 64, v5
    v_xor_b32 v51, 96, v6
    v_xor_b32 v59, 96, v5
    s_mul_i32 s44, s49, 3
    s_add_u32 s44, s44, 0
    v_xor_b32 v12, s44, v9
    v_lshl_add_u32 v52, v12, 5, v10
    s_mul_i32 s44, s49, 3
    s_add_u32 s44, s44, 1
    v_xor_b32 v12, s44, v9
    v_lshl_add_u32 v53, v12, 5, v10
    s_mul_i32 s44, s49, 3
    s_add_u32 s44, s44, 2
    v_xor_b32 v12, s44, v9
    v_lshl_add_u32 v54, v12, 5, v10
    v_mov_b32 v128, 0
    v_mov_b32 v129, 0
    v_mov_b32 v130, 0
    v_mov_b32 v131, 0
    v_mov_b32 v132, 0
    v_mov_b32 v133, 0
    v_mov_b32 v134, 0
    v_mov_b32 v135, 0
    v_mov_b32 v136, 0
    v_mov_b32 v137, 0
    v_mov_b32 v138, 0
    v_mov_b32 v139, 0
    v_mov_b32 v140, 0
    v_mov_b32 v141, 0
    v_mov_b32 v142, 0
    v_mov_b32 v143, 0
    v_mov_b32 v144, 0
    v_mov_b32 v145, 0
    v_mov_b32 v146, 0
    v_mov_b32 v147, 0
    v_mov_b32 v148, 0
    v_mov_b32 v149, 0
    v_mov_b32 v150, 0
    v_mov_b32 v151, 0
    v_mov_b32 v152, 0
    v_mov_b32 v153, 0
    v_mov_b32 v154, 0
    v_mov_b32 v155, 0
    v_mov_b32 v156, 0
    v_mov_b32 v157, 0
    v_mov_b32 v158, 0
    v_mov_b32 v159, 0
    v_mov_b32 v160, 0
    v_mov_b32 v161, 0
    v_mov_b32 v162, 0
    v_mov_b32 v163, 0
    v_mov_b32 v164, 0
    v_mov_b32 v165, 0
    v_mov_b32 v166, 0
    v_mov_b32 v167, 0
    v_mov_b32 v168, 0
    v_mov_b32 v169, 0
    v_mov_b32 v170, 0
    v_mov_b32 v171, 0
    v_mov_b32 v172, 0
    v_mov_b32 v173, 0
    v_mov_b32 v174, 0
    v_mov_b32 v175, 0
    v_mov_b32 v176, 0
    v_mov_b32 v177, 0
    v_mov_b32 v178, 0
    v_mov_b32 v179, 0
    v_mov_b32 v180, 0
    v_mov_b32 v181, 0
    v_mov_b32 v182, 0
    v_mov_b32 v183, 0
    v_mov_b32 v184, 0
    v_mov_b32 v185, 0
    v_mov_b32 v186, 0
    v_mov_b32 v187, 0
    v_mov_b32 v188, 0
    v_mov_b32 v189, 0
    v_mov_b32 v190, 0
    v_mov_b32 v191, 0
    v_mov_b32 v192, 0
    v_mov_b32 v193, 0
    v_mov_b32 v194, 0
    v_mov_b32 v195, 0
    v_mov_b32 v196, 0
    v_mov_b32 v197, 0
    v_mov_b32 v198, 0
    v_mov_b32 v199, 0
    v_mov_b32 v200, 0
    v_mov_b32 v201, 0
    v_mov_b32 v202, 0
    v_mov_b32 v203, 0
    v_mov_b32 v204, 0
    v_mov_b32 v205, 0
    v_mov_b32 v206, 0
    v_mov_b32 v207, 0
    v_mov_b32 v208, 0
    v_mov_b32 v209, 0
    v_mov_b32 v210, 0
    v_mov_b32 v211, 0
    v_mov_b32 v212, 0
    v_mov_b32 v213, 0
    v_mov_b32 v214, 0
    v_mov_b32 v215, 0
    v_mov_b32 v216, 0
    v_mov_b32 v217, 0
    v_mov_b32 v218, 0
    v_mov_b32 v219, 0
    v_mov_b32 v220, 0
    v_mov_b32 v221, 0
    v_mov_b32 v222, 0
    v_mov_b32 v223, 0
    v_mov_b32 v224, 0
    v_mov_b32 v225, 0
    v_mov_b32 v226, 0
    v_mov_b32 v227, 0
    v_mov_b32 v228, 0
    v_mov_b32 v229, 0
    v_mov_b32 v230, 0
    v_mov_b32 v231, 0
    v_mov_b32 v232, 0
    v_mov_b32 v233, 0
    v_mov_b32 v234, 0
    v_mov_b32 v235, 0
    v_mov_b32 v236, 0
    v_mov_b32 v237, 0
    v_mov_b32 v238, 0
    v_mov_b32 v239, 0
    v_cvt_f32_u32 v12, v3
    v_mul_f32 v12, 0xbd000000, v12
    v_lshlrev_b32 v13, 2, v4
    v_cvt_f32_u32 v13, v13
    v_mul_f32 v13, v12, v13
    v_fmamk_f32 v14, v12, 0x00000000, v13
    v_cos_f32 v16, v14
    v_sin_f32 v18, v14
    v_fmamk_f32 v15, v12, 0x3f800000, v13
    v_cos_f32 v17, v15
    v_sin_f32 v19, v15
    v_cvt_pk_bf16_f32 v32, v16, v17
    v_cvt_pk_bf16_f32 v40, v18, v19
    v_fmamk_f32 v14, v12, 0x40000000, v13
    v_cos_f32 v16, v14
    v_sin_f32 v18, v14
    v_fmamk_f32 v15, v12, 0x40400000, v13
    v_cos_f32 v17, v15
    v_sin_f32 v19, v15
    v_cvt_pk_bf16_f32 v33, v16, v17
    v_cvt_pk_bf16_f32 v41, v18, v19
    v_fmamk_f32 v14, v12, 0x41000000, v13
    v_cos_f32 v16, v14
    v_sin_f32 v18, v14
    v_fmamk_f32 v15, v12, 0x41100000, v13
    v_cos_f32 v17, v15
    v_sin_f32 v19, v15
    v_cvt_pk_bf16_f32 v34, v16, v17
    v_cvt_pk_bf16_f32 v42, v18, v19
    v_fmamk_f32 v14, v12, 0x41200000, v13
    v_cos_f32 v16, v14
    v_sin_f32 v18, v14
    v_fmamk_f32 v15, v12, 0x41300000, v13
    v_cos_f32 v17, v15
    v_sin_f32 v19, v15
    v_cvt_pk_bf16_f32 v35, v16, v17
    v_cvt_pk_bf16_f32 v43, v18, v19
    v_fmamk_f32 v14, v12, 0x41800000, v13
    v_cos_f32 v16, v14
    v_sin_f32 v18, v14
    v_fmamk_f32 v15, v12, 0x41880000, v13
    v_cos_f32 v17, v15
    v_sin_f32 v19, v15
    v_cvt_pk_bf16_f32 v36, v16, v17
    v_cvt_pk_bf16_f32 v44, v18, v19
    v_fmamk_f32 v14, v12, 0x41900000, v13
    v_cos_f32 v16, v14
    v_sin_f32 v18, v14
    v_fmamk_f32 v15, v12, 0x41980000, v13
    v_cos_f32 v17, v15
    v_sin_f32 v19, v15
    v_cvt_pk_bf16_f32 v37, v16, v17
    v_cvt_pk_bf16_f32 v45, v18, v19
    v_fmamk_f32 v14, v12, 0x41c00000, v13
    v_cos_f32 v16, v14
    v_sin_f32 v18, v14
    v_fmamk_f32 v15, v12, 0x41c80000, v13
    v_cos_f32 v17, v15
    v_sin_f32 v19, v15
    v_cvt_pk_bf16_f32 v38, v16, v17
    v_cvt_pk_bf16_f32 v46, v18, v19
    v_fmamk_f32 v14, v12, 0x41d00000, v13
    v_cos_f32 v16, v14
    v_sin_f32 v18, v14
    v_fmamk_f32 v15, v12, 0x41d80000, v13
    v_cos_f32 v17, v15
    v_sin_f32 v19, v15
    v_cvt_pk_bf16_f32 v39, v16, v17
    v_cvt_pk_bf16_f32 v47, v18, v19
    v_and_b32 v24, 15, v1
    s_lshl_b32 s44, s17, 4
    v_add_u32 v24, s44, v24
    v_and_b32 v25, 16, v1
    v_or_b32 v26, v24, v25
    v_cmp_eq_u32 vcc, 0, v26
    v_mov_b32 v26, 256
    s_nop 0
    v_cndmask_b32 v24, v24, v26, vcc
    v_cvt_f32_u32 v24, v24
    v_mul_f32 v24, 0x3b000000, v24
    v_cvt_f32_u32 v25, v25
    v_mul_f32 v25, 0x3c800000, v25
    s_lshl_b32 s44, s18, 6
    v_lshl_add_u32 v26, v4, 3, s44
    v_cvt_f32_u32 v26, v26
    v_fma_f32 v26, v24, v26, v25
    v_fmamk_f32 v8, v24, 0x00000000, v26
    v_fmamk_f32 v16, v24, 0xc1800000, v26
    v_fmamk_f32 v9, v24, 0x3f800000, v26
    v_fmamk_f32 v17, v24, 0xc1700000, v26
    v_fmamk_f32 v10, v24, 0x40000000, v26
    v_fmamk_f32 v18, v24, 0xc1600000, v26
    v_fmamk_f32 v11, v24, 0x40400000, v26
    v_fmamk_f32 v19, v24, 0xc1500000, v26
    v_fmamk_f32 v12, v24, 0x40800000, v26
    v_fmamk_f32 v20, v24, 0xc1400000, v26
    v_fmamk_f32 v13, v24, 0x40a00000, v26
    v_fmamk_f32 v21, v24, 0xc1300000, v26
    v_fmamk_f32 v14, v24, 0x40c00000, v26
    v_fmamk_f32 v22, v24, 0xc1200000, v26
    v_fmamk_f32 v15, v24, 0x40e00000, v26
    v_fmamk_f32 v23, v24, 0xc1100000, v26
    v_mul_f32 v27, 0x41800000, v24
    v_cos_f32 v8, v8
    v_cos_f32 v9, v9
    v_cos_f32 v10, v10
    v_cos_f32 v11, v11
    v_cos_f32 v12, v12
    v_cos_f32 v13, v13
    v_cos_f32 v14, v14
    v_cos_f32 v15, v15
    v_cos_f32 v16, v16
    v_cos_f32 v17, v17
    v_cos_f32 v18, v18
    v_cos_f32 v19, v19
    v_cos_f32 v20, v20
    v_cos_f32 v21, v21
    v_cos_f32 v22, v22
    v_cos_f32 v23, v23
    v_cos_f32 v27, v27
    s_nop 0
    v_add_f32 v27, v27, v27
    v_cvt_pk_bf16_f32 v72, v8, v9
    v_cvt_pk_bf16_f32 v73, v10, v11
    v_cvt_pk_bf16_f32 v74, v12, v13
    v_cvt_pk_bf16_f32 v75, v14, v15
    s_waitcnt vmcnt(5)
    v_lshlrev_b32 v96, 16, v76
    v_and_b32 v97, 0xffff0000, v76
    v_lshlrev_b32 v98, 16, v77
    v_and_b32 v99, 0xffff0000, v77
    v_lshlrev_b32 v100, 16, v78
    v_and_b32 v101, 0xffff0000, v78
    v_lshlrev_b32 v102, 16, v79
    v_and_b32 v103, 0xffff0000, v79
    v_lshlrev_b32 v104, 16, v80
    v_and_b32 v105, 0xffff0000, v80
    v_lshlrev_b32 v106, 16, v81
    v_and_b32 v107, 0xffff0000, v81
    v_lshlrev_b32 v108, 16, v82
    v_and_b32 v109, 0xffff0000, v82
    v_lshlrev_b32 v110, 16, v83
    v_and_b32 v111, 0xffff0000, v83
    v_add_f32 v112, v96, v97
    v_add_f32 v113, v104, v105
    v_add_f32 v112, v112, v98
    v_add_f32 v113, v113, v106
    v_add_f32 v112, v112, v99
    v_add_f32 v113, v113, v107
    v_add_f32 v112, v112, v100
    v_add_f32 v113, v113, v108
    v_add_f32 v112, v112, v101
    v_add_f32 v113, v113, v109
    v_add_f32 v112, v112, v102
    v_add_f32 v113, v113, v110
    v_add_f32 v112, v112, v103
    v_add_f32 v113, v113, v111
    s_nop 0
    v_add_f32_dpp v112, v112, v112 quad_perm:[1,0,3,2] row_mask:0xf bank_mask:0xf
    v_add_f32_dpp v113, v113, v113 quad_perm:[1,0,3,2] row_mask:0xf bank_mask:0xf
    s_nop 0
    v_add_f32_dpp v112, v112, v112 quad_perm:[2,3,0,1] row_mask:0xf bank_mask:0xf
    v_add_f32_dpp v113, v113, v113 quad_perm:[2,3,0,1] row_mask:0xf bank_mask:0xf
    s_nop 0
    v_add_f32_dpp v112, v112, v112 row_half_mirror row_mask:0xf bank_mask:0xf
    v_add_f32_dpp v113, v113, v113 row_half_mirror row_mask:0xf bank_mask:0xf
    s_nop 0
    v_add_f32_dpp v112, v112, v112 row_mirror row_mask:0xf bank_mask:0xf
    v_add_f32_dpp v113, v113, v113 row_mirror row_mask:0xf bank_mask:0xf
    v_mov_b32 v116, v112
    v_mov_b32 v117, v113
    s_nop 0
    v_permlane16_swap_b32 v112, v116
    v_permlane16_swap_b32 v113, v117
    v_add_f32 v112, v112, v116
    v_add_f32 v113, v113, v117
    v_mov_b32 v116, v112
    v_mov_b32 v117, v113
    s_nop 0
    v_permlane32_swap_b32 v112, v116
    v_permlane32_swap_b32 v113, v117
    v_add_f32 v112, v112, v116
    v_add_f32 v113, v113, v117
    v_mul_f32 v112, 0x3b000000, v112
    v_mul_f32 v113, 0x3b000000, v113
    v_sub_f32 v96, v96, v112
    v_sub_f32 v104, v104, v113
    v_sub_f32 v97, v97, v112
    v_sub_f32 v105, v105, v113
    v_sub_f32 v98, v98, v112
    v_sub_f32 v106, v106, v113
    v_sub_f32 v99, v99, v112
    v_sub_f32 v107, v107, v113
    v_sub_f32 v100, v100, v112
    v_sub_f32 v108, v108, v113
    v_sub_f32 v101, v101, v112
    v_sub_f32 v109, v109, v113
    v_sub_f32 v102, v102, v112
    v_sub_f32 v110, v110, v113
    v_sub_f32 v103, v103, v112
    v_sub_f32 v111, v111, v113
    v_mul_f32 v114, v96, v96
    v_mul_f32 v115, v104, v104
    v_fmac_f32 v114, v97, v97
    v_fmac_f32 v115, v105, v105
    v_fmac_f32 v114, v98, v98
    v_fmac_f32 v115, v106, v106
    v_fmac_f32 v114, v99, v99
    v_fmac_f32 v115, v107, v107
    v_fmac_f32 v114, v100, v100
    v_fmac_f32 v115, v108, v108
    v_fmac_f32 v114, v101, v101
    v_fmac_f32 v115, v109, v109
    v_fmac_f32 v114, v102, v102
    v_fmac_f32 v115, v110, v110
    v_fmac_f32 v114, v103, v103
    v_fmac_f32 v115, v111, v111
    s_nop 0
    v_add_f32_dpp v114, v114, v114 quad_perm:[1,0,3,2] row_mask:0xf bank_mask:0xf
    v_add_f32_dpp v115, v115, v115 quad_perm:[1,0,3,2] row_mask:0xf bank_mask:0xf
    s_nop 0
    v_add_f32_dpp v114, v114, v114 quad_perm:[2,3,0,1] row_mask:0xf bank_mask:0xf
    v_add_f32_dpp v115, v115, v115 quad_perm:[2,3,0,1] row_mask:0xf bank_mask:0xf
    s_nop 0
    v_add_f32_dpp v114, v114, v114 row_half_mirror row_mask:0xf bank_mask:0xf
    v_add_f32_dpp v115, v115, v115 row_half_mirror row_mask:0xf bank_mask:0xf
    s_nop 0
    v_add_f32_dpp v114, v114, v114 row_mirror row_mask:0xf bank_mask:0xf
    v_add_f32_dpp v115, v115, v115 row_mirror row_mask:0xf bank_mask:0xf
    v_mov_b32 v116, v114
    v_mov_b32 v117, v115
    s_nop 0
    v_permlane16_swap_b32 v114, v116
    v_permlane16_swap_b32 v115, v117
    v_add_f32 v114, v114, v116
    v_add_f32 v115, v115, v117
    v_mov_b32 v116, v114
    v_mov_b32 v117, v115
    s_nop 0
    v_permlane32_swap_b32 v114, v116
    v_permlane32_swap_b32 v115, v117
    v_add_f32 v114, v114, v116
    v_add_f32 v115, v115, v117
    v_mov_b32 v118, 0x3727c5ac
    v_fmamk_f32 v114, v114, 0x3b000000, v118
    v_fmamk_f32 v115, v115, 0x3b000000, v118
    v_rsq_f32 v114, v114
    v_rsq_f32 v115, v115
    v_cmp_eq_u32 vcc, 0, v1
    s_lshl_b32 s44, s16, 7
    s_lshl_b32 s45, s17, 3
    s_add_u32 s44, s44, s45
    s_lshl_b32 s45, s46, 1
    s_add_u32 s44, s44, s45
    s_lshl_b32 s44, s44, 4
    s_add_u32 s44, s44, 8650752
    s_waitcnt lgkmcnt(0)
    s_add_u32 s62, s62, 1
    v_cndmask_b32 v120, v113, v112, vcc
    v_cndmask_b32 v121, v115, v114, vcc
    v_mov_b32 v122, s62
    v_mov_b32 v123, 0
    s_mov_b64 exec, 3
    buffer_store_dwordx4 v[120:123], v63, s[40:43], s44 offen sc1
    s_mov_b64 exec, -1
    s_add_u32 s44, s54, 106496
    v_add_u32 v96, s44, v63
    v_lshrrev_b32 v97, 2, v3
    v_and_b32 v97, 3, v97
    v_lshlrev_b32 v97, 4, v97
    v_lshl_add_u32 v97, v3, 6, v97
    v_lshl_add_u32 v250, v4, 3, v97
    v_add_u32 v97, s44, v250
    s_waitcnt vmcnt(4)
    ds_write_b128 v96, v[84:87]
    ds_write_b128 v96, v[88:91] offset:1024
    v_xor_b32 v98, 0, v97
    v_xor_b32 v99, 16, v97
    v_xor_b32 v100, 32, v97
    v_xor_b32 v101, 48, v97
    s_waitcnt lgkmcnt(0)
    ds_read_b64 v[240:241], v98
    ds_read_b64 v[242:243], v99
    ds_read_b64 v[244:245], v100
    ds_read_b64 v[246:247], v101
    s_lshl_b32 s60, s16, 12
    s_add_u32 s60, s60, 8388608
    s_lshl_b32 s44, s17, 4
    s_lshl_b32 s45, s46, 2
    s_add_u32 s44, s44, s45
    v_mov_b32 v251, s44
    v_mov_b32 v252, s62
    s_lshl_b32 s44, s46, 8
    s_add_u32 s44, s44, 161280
    v_lshl_add_u32 v28, v3, 3, s44
    v_mov_b32 v29, 162816
    v_cmp_eq_u32 vcc, 0, v4
    s_nop 1
    v_cndmask_b32 v28, v29, v28, vcc
    v_xor_b32 v62, 256, v28
    s_mul_i32 s44, s49, 768
    s_add_u32 s44, s44, 159744
    v_lshl_add_u32 v29, v3, 3, s44
    s_lshl_b32 s44, s46, 7
    s_add_u32 s44, s44, 162304
    v_lshl_add_u32 v30, v4, 4, s44
    s_lshl_b32 s44, s49, 1
    s_add_u32 s44, s44, s9
    s_lshl_b32 s44, s44, 7
    s_add_u32 s44, s44, 162304
    v_lshl_add_u32 v31, v3, 2, s44
    s_setprio 1
    s_mov_b32 s50, 0
    s_mov_b32 s51, 7
    s_waitcnt lgkmcnt(0)
    s_barrier
    ds_read_b128 v[64:67], v48
    ds_read_b128 v[68:71], v56
    ds_read_b64_tr_b16 v[76:77], v52 offset:0
    ds_read_b64_tr_b16 v[78:79], v52 offset:13312
    ds_read_b64_tr_b16 v[80:81], v53 offset:0
    ds_read_b64_tr_b16 v[82:83], v53 offset:13312
    ds_read_b64_tr_b16 v[84:85], v54 offset:0
    ds_read_b64_tr_b16 v[86:87], v54 offset:13312
.p2align 3
K_cloop:
    s_waitcnt lgkmcnt(0)
    v_mfma_f32_32x32x16_bf16 v[224:239], v[64:67], v[72:75], v[224:239]
    ds_read_b128 v[96:99], v49
    ds_read_b128 v[100:103], v57
    ds_read_b64_tr_b16 v[108:109], v52 offset:2048
    v_fma_f32 v16, v27, v8, -v16
    v_fma_f32 v17, v27, v9, -v17
    v_mfma_f32_32x32x16_bf16 v[128:143], v[76:79], v[64:67], v[128:143]
    ds_read_b64_tr_b16 v[110:111], v52 offset:15360
    ds_read_b64_tr_b16 v[112:113], v53 offset:2048
    ds_read_b64_tr_b16 v[114:115], v53 offset:15360
    v_fma_f32 v18, v27, v10, -v18
    v_fma_f32 v19, v27, v11, -v19
    v_mfma_f32_32x32x16_bf16 v[176:191], v[76:79], v[68:71], v[176:191]
    ds_read_b64_tr_b16 v[116:117], v54 offset:2048
    ds_read_b64_tr_b16 v[118:119], v54 offset:15360
    v_fma_f32 v20, v27, v12, -v20
    v_fma_f32 v21, v27, v13, -v21
    v_fma_f32 v22, v27, v14, -v22
    v_mfma_f32_32x32x16_bf16 v[144:159], v[80:83], v[64:67], v[144:159]
    v_fma_f32 v23, v27, v15, -v23
    v_cvt_pk_bf16_f32 v104, v16, v17
    v_cvt_pk_bf16_f32 v105, v18, v19
    v_cvt_pk_bf16_f32 v106, v20, v21
    v_cvt_pk_bf16_f32 v107, v22, v23
    v_mfma_f32_32x32x16_bf16 v[192:207], v[80:83], v[68:71], v[192:207]
    s_add_u32 s50, s50, 1
    s_cmp_eq_u32 s50, 3
    s_cselect_b32 s44, 4294860800, s61
    s_cselect_b32 s50, 0, s50
    v_add_u32 v48, s44, v48
    v_mfma_f32_32x32x16_bf16 v[160:175], v[84:87], v[64:67], v[160:175]
    v_add_u32 v56, s44, v56
    v_mfma_f32_32x32x16_bf16 v[208:223], v[84:87], v[68:71], v[208:223]
    s_waitcnt lgkmcnt(0)
    v_mfma_f32_32x32x16_bf16 v[224:239], v[96:99], v[104:107], v[224:239]
    ds_read_b128 v[64:67], v50
    ds_read_b128 v[68:71], v58
    ds_read_b64_tr_b16 v[76:77], v52 offset:4096
    v_fma_f32 v8, v27, v16, -v8
    v_fma_f32 v9, v27, v17, -v9
    v_mfma_f32_32x32x16_bf16 v[128:143], v[108:111], v[96:99], v[128:143]
    ds_read_b64_tr_b16 v[78:79], v52 offset:17408
    ds_read_b64_tr_b16 v[80:81], v53 offset:4096
    ds_read_b64_tr_b16 v[82:83], v53 offset:17408
    v_fma_f32 v10, v27, v18, -v10
    v_fma_f32 v11, v27, v19, -v11
    v_mfma_f32_32x32x16_bf16 v[176:191], v[108:111], v[100:103], v[176:191]
    ds_read_b64_tr_b16 v[84:85], v54 offset:4096
    ds_read_b64_tr_b16 v[86:87], v54 offset:17408
    v_fma_f32 v12, v27, v20, -v12
    v_fma_f32 v13, v27, v21, -v13
    v_fma_f32 v14, v27, v22, -v14
    v_mfma_f32_32x32x16_bf16 v[144:159], v[112:115], v[96:99], v[144:159]
    v_fma_f32 v15, v27, v23, -v15
    v_cvt_pk_bf16_f32 v72, v8, v9
    v_cvt_pk_bf16_f32 v73, v10, v11
    v_cvt_pk_bf16_f32 v74, v12, v13
    v_cvt_pk_bf16_f32 v75, v14, v15
    v_mfma_f32_32x32x16_bf16 v[192:207], v[112:115], v[100:103], v[192:207]
    v_add_u32 v49, s44, v49
    v_add_u32 v57, s44, v57
    v_mfma_f32_32x32x16_bf16 v[160:175], v[116:119], v[96:99], v[160:175]
    v_mfma_f32_32x32x16_bf16 v[208:223], v[116:119], v[100:103], v[208:223]
    s_waitcnt lgkmcnt(0)
    v_mfma_f32_32x32x16_bf16 v[224:239], v[64:67], v[72:75], v[224:239]
    ds_read_b128 v[96:99], v51
    ds_read_b128 v[100:103], v59
    ds_read_b64_tr_b16 v[108:109], v52 offset:6144
    v_fma_f32 v16, v27, v8, -v16
    v_fma_f32 v17, v27, v9, -v17
    v_mfma_f32_32x32x16_bf16 v[128:143], v[76:79], v[64:67], v[128:143]
    ds_read_b64_tr_b16 v[110:111], v52 offset:19456
    ds_read_b64_tr_b16 v[112:113], v53 offset:6144
    ds_read_b64_tr_b16 v[114:115], v53 offset:19456
    v_add_u32 v52, s44, v52
    v_add_u32 v53, s44, v53
    v_mfma_f32_32x32x16_bf16 v[176:191], v[76:79], v[68:71], v[176:191]
    ds_read_b64_tr_b16 v[116:117], v54 offset:6144
    ds_read_b64_tr_b16 v[118:119], v54 offset:19456
    v_add_u32 v54, s44, v54
    v_fma_f32 v18, v27, v10, -v18
    v_fma_f32 v19, v27, v11, -v19
    v_mfma_f32_32x32x16_bf16 v[144:159], v[80:83], v[64:67], v[144:159]
    v_fma_f32 v20, v27, v12, -v20
    v_fma_f32 v21, v27, v13, -v21
    v_fma_f32 v22, v27, v14, -v22
    v_fma_f32 v23, v27, v15, -v23
    v_cvt_pk_bf16_f32 v104, v16, v17
    v_mfma_f32_32x32x16_bf16 v[192:207], v[80:83], v[68:71], v[192:207]
    v_cvt_pk_bf16_f32 v105, v18, v19
    v_cvt_pk_bf16_f32 v106, v20, v21
    v_cvt_pk_bf16_f32 v107, v22, v23
    v_add_u32 v50, s44, v50
    v_add_u32 v58, s44, v58
    v_mfma_f32_32x32x16_bf16 v[160:175], v[84:87], v[64:67], v[160:175]
    v_mfma_f32_32x32x16_bf16 v[208:223], v[84:87], v[68:71], v[208:223]
    s_waitcnt lgkmcnt(0)
    s_barrier
    v_mfma_f32_32x32x16_bf16 v[224:239], v[96:99], v[104:107], v[224:239]
    ds_read_b128 v[64:67], v48
    ds_read_b128 v[68:71], v56
    ds_read_b64_tr_b16 v[76:77], v52 offset:0
    v_fma_f32 v8, v27, v16, -v8
    v_fma_f32 v9, v27, v17, -v9
    v_mfma_f32_32x32x16_bf16 v[128:143], v[108:111], v[96:99], v[128:143]
    ds_read_b64_tr_b16 v[78:79], v52 offset:13312
    ds_read_b64_tr_b16 v[80:81], v53 offset:0
    ds_read_b64_tr_b16 v[82:83], v53 offset:13312
    v_fma_f32 v10, v27, v18, -v10
    v_fma_f32 v11, v27, v19, -v11
    v_mfma_f32_32x32x16_bf16 v[176:191], v[108:111], v[100:103], v[176:191]
    ds_read_b64_tr_b16 v[84:85], v54 offset:0
    ds_read_b64_tr_b16 v[86:87], v54 offset:13312
    v_fma_f32 v12, v27, v20, -v12
    v_fma_f32 v13, v27, v21, -v13
    v_fma_f32 v14, v27, v22, -v14
    v_mfma_f32_32x32x16_bf16 v[144:159], v[112:115], v[96:99], v[144:159]
    v_fma_f32 v15, v27, v23, -v15
    v_cvt_pk_bf16_f32 v72, v8, v9
    v_cvt_pk_bf16_f32 v73, v10, v11
    v_cvt_pk_bf16_f32 v74, v12, v13
    v_cvt_pk_bf16_f32 v75, v14, v15
    v_mfma_f32_32x32x16_bf16 v[192:207], v[112:115], v[100:103], v[192:207]
    v_add_u32 v51, s44, v51
    v_add_u32 v59, s44, v59
    s_sub_u32 s51, s51, 1
    s_cmp_lg_u32 s51, 0
    v_mfma_f32_32x32x16_bf16 v[160:175], v[116:119], v[96:99], v[160:175]
    v_mfma_f32_32x32x16_bf16 v[208:223], v[116:119], v[100:103], v[208:223]
    s_cbranch_scc1 K_cloop
    s_waitcnt lgkmcnt(0)
    v_mfma_f32_32x32x16_bf16 v[224:239], v[64:67], v[72:75], v[224:239]
    ds_read_b128 v[96:99], v49
    ds_read_b128 v[100:103], v57
    ds_read_b64_tr_b16 v[108:109], v52 offset:2048
    v_fma_f32 v16, v27, v8, -v16
    v_fma_f32 v17, v27, v9, -v17
    v_mfma_f32_32x32x16_bf16 v[128:143], v[76:79], v[64:67], v[128:143]
    ds_read_b64_tr_b16 v[110:111], v52 offset:15360
    ds_read_b64_tr_b16 v[112:113], v53 offset:2048
    ds_read_b64_tr_b16 v[114:115], v53 offset:15360
    v_fma_f32 v18, v27, v10, -v18
    v_fma_f32 v19, v27, v11, -v19
    v_mfma_f32_32x32x16_bf16 v[176:191], v[76:79], v[68:71], v[176:191]
    ds_read_b64_tr_b16 v[116:117], v54 offset:2048
    ds_read_b64_tr_b16 v[118:119], v54 offset:15360
    v_fma_f32 v20, v27, v12, -v20
    v_fma_f32 v21, v27, v13, -v21
    v_fma_f32 v22, v27, v14, -v22
    v_mfma_f32_32x32x16_bf16 v[144:159], v[80:83], v[64:67], v[144:159]
    v_fma_f32 v23, v27, v15, -v23
    v_cvt_pk_bf16_f32 v104, v16, v17
    v_cvt_pk_bf16_f32 v105, v18, v19
    v_cvt_pk_bf16_f32 v106, v20, v21
    v_cvt_pk_bf16_f32 v107, v22, v23
    v_mfma_f32_32x32x16_bf16 v[192:207], v[80:83], v[68:71], v[192:207]
    v_mfma_f32_32x32x16_bf16 v[160:175], v[84:87], v[64:67], v[160:175]
    v_mfma_f32_32x32x16_bf16 v[208:223], v[84:87], v[68:71], v[208:223]
    s_waitcnt lgkmcnt(0)
    v_mfma_f32_32x32x16_bf16 v[224:239], v[96:99], v[104:107], v[224:239]
    ds_read_b128 v[64:67], v50
    ds_read_b128 v[68:71], v58
    ds_read_b64_tr_b16 v[76:77], v52 offset:4096
    v_fma_f32 v8, v27, v16, -v8
    v_fma_f32 v9, v27, v17, -v9
    v_mfma_f32_32x32x16_bf16 v[128:143], v[108:111], v[96:99], v[128:143]
    ds_read_b64_tr_b16 v[78:79], v52 offset:17408
    ds_read_b64_tr_b16 v[80:81], v53 offset:4096
    ds_read_b64_tr_b16 v[82:83], v53 offset:17408
    v_fma_f32 v10, v27, v18, -v10
    v_fma_f32 v11, v27, v19, -v11
    v_mfma_f32_32x32x16_bf16 v[176:191], v[108:111], v[100:103], v[176:191]
    ds_read_b64_tr_b16 v[84:85], v54 offset:4096
    ds_read_b64_tr_b16 v[86:87], v54 offset:17408
    v_fma_f32 v12, v27, v20, -v12
    v_fma_f32 v13, v27, v21, -v13
    v_fma_f32 v14, v27, v22, -v14
    v_mfma_f32_32x32x16_bf16 v[144:159], v[112:115], v[96:99], v[144:159]
    v_fma_f32 v15, v27, v23, -v15
    v_cvt_pk_bf16_f32 v72, v8, v9
    v_cvt_pk_bf16_f32 v73, v10, v11
    v_cvt_pk_bf16_f32 v74, v12, v13
    v_cvt_pk_bf16_f32 v75, v14, v15
    v_mfma_f32_32x32x16_bf16 v[192:207], v[112:115], v[100:103], v[192:207]
    v_mfma_f32_32x32x16_bf16 v[160:175], v[116:119], v[96:99], v[160:175]
    v_mfma_f32_32x32x16_bf16 v[208:223], v[116:119], v[100:103], v[208:223]
    s_waitcnt lgkmcnt(0)
    v_mfma_f32_32x32x16_bf16 v[224:239], v[64:67], v[72:75], v[224:239]
    ds_read_b128 v[96:99], v51
    ds_read_b128 v[100:103], v59
    ds_read_b64_tr_b16 v[108:109], v52 offset:6144
    v_fma_f32 v16, v27, v8, -v16
    v_fma_f32 v17, v27, v9, -v17
    v_mfma_f32_32x32x16_bf16 v[128:143], v[76:79], v[64:67], v[128:143]
    ds_read_b64_tr_b16 v[110:111], v52 offset:19456
    ds_read_b64_tr_b16 v[112:113], v53 offset:6144
    ds_read_b64_tr_b16 v[114:115], v53 offset:19456
    v_fma_f32 v18, v27, v10, -v18
    v_fma_f32 v19, v27, v11, -v19
    v_mfma_f32_32x32x16_bf16 v[176:191], v[76:79], v[68:71], v[176:191]
    ds_read_b64_tr_b16 v[116:117], v54 offset:6144
    ds_read_b64_tr_b16 v[118:119], v54 offset:19456
    v_fma_f32 v20, v27, v12, -v20
    v_fma_f32 v21, v27, v13, -v21
    v_fma_f32 v22, v27, v14, -v22
    v_mfma_f32_32x32x16_bf16 v[144:159], v[80:83], v[64:67], v[144:159]
    v_fma_f32 v23, v27, v15, -v23
    v_cvt_pk_bf16_f32 v104, v16, v17
    v_cvt_pk_bf16_f32 v105, v18, v19
    v_cvt_pk_bf16_f32 v106, v20, v21
    v_cvt_pk_bf16_f32 v107, v22, v23
    v_mfma_f32_32x32x16_bf16 v[192:207], v[80:83], v[68:71], v[192:207]
    v_mfma_f32_32x32x16_bf16 v[160:175], v[84:87], v[64:67], v[160:175]
    v_mfma_f32_32x32x16_bf16 v[208:223], v[84:87], v[68:71], v[208:223]
    s_waitcnt lgkmcnt(0)
    s_barrier
    v_mfma_f32_32x32x16_bf16 v[224:239], v[96:99], v[104:107], v[224:239]
    ds_read_b64 v[80:81], v28
    ds_read_b64 v[84:85], v62
    ds_read_b64 v[64:65], v29 offset:0
    v_mov_b32 v82, 0
    v_mov_b32 v83, 0
    v_mfma_f32_32x32x16_bf16 v[128:143], v[108:111], v[96:99], v[128:143]
    ds_read_b64 v[68:69], v29 offset:256
    ds_read_b64 v[72:73], v29 offset:512
    ds_read_b128 v[8:11], v30 offset:0
    v_mov_b32 v86, 0
    v_mov_b32 v87, 0
    v_mfma_f32_32x32x16_bf16 v[176:191], v[108:111], v[100:103], v[176:191]
    ds_read_b128 v[12:15], v30 offset:32
    ds_read_b128 v[16:19], v30 offset:64
    ds_read_b128 v[20:23], v30 offset:96
    v_mfma_f32_32x32x16_bf16 v[144:159], v[112:115], v[96:99], v[144:159]
    ds_read_b32 v2, v31
    v_mfma_f32_32x32x16_bf16 v[192:207], v[112:115], v[100:103], v[192:207]
    v_mfma_f32_32x32x16_bf16 v[160:175], v[116:119], v[96:99], v[160:175]
    v_mfma_f32_32x32x16_bf16 v[208:223], v[116:119], v[100:103], v[208:223]
    s_waitcnt lgkmcnt(0)
    s_mul_i32 s44, s49, 176128
    s_sub_u32 s100, s101, s44
    s_add_u32 s100, s100, 88064
    s_lshl_b32 s44, s49, 3
    s_add_u32 s44, s44, s21
    s_cmp_eq_u32 s44, 13
    s_cselect_b32 s45, 1073741824, 0
    v_mfma_f32_32x32x16_bf16 v[128:143], v[64:67], v[80:83], v[128:143]
    v_mul_f32 v224, v224, v8
    v_mul_f32 v225, v225, v9
    v_mul_f32 v226, v226, v10
    v_mul_f32 v227, v227, v11
    v_mul_f32 v228, v228, v12
    v_mul_f32 v229, v229, v13
    v_mfma_f32_32x32x16_bf16 v[144:159], v[68:71], v[80:83], v[144:159]
    v_mul_f32 v230, v230, v14
    v_mul_f32 v231, v231, v15
    v_mul_f32 v232, v232, v16
    v_mul_f32 v233, v233, v17
    v_mul_f32 v234, v234, v18
    v_mul_f32 v235, v235, v19
    v_mfma_f32_32x32x16_bf16 v[160:175], v[72:75], v[80:83], v[160:175]
    v_mul_f32 v236, v236, v20
    v_mul_f32 v237, v237, v21
    v_mul_f32 v238, v238, v22
    v_mul_f32 v239, v239, v23
    v_mfma_f32_32x32x16_bf16 v[176:191], v[64:67], v[84:87], v[176:191]
    v_mfma_f32_32x32x16_bf16 v[192:207], v[68:71], v[84:87], v[192:207]
    v_mfma_f32_32x32x16_bf16 v[208:223], v[72:75], v[84:87], v[208:223]
    v_mul_f32 v128, v128, v136
    v_mul_f32 v129, v129, v137
    v_mul_f32 v130, v130, v138
    v_mul_f32 v131, v131, v139
    v_mul_f32 v132, v132, v140
    v_mul_f32 v133, v133, v141
    v_mul_f32 v134, v134, v142
    v_mul_f32 v135, v135, v143
    v_cvt_pk_bf16_f32 v96, v128, v129
    v_cvt_pk_bf16_f32 v97, v130, v131
    v_cvt_pk_bf16_f32 v98, v132, v133
    v_cvt_pk_bf16_f32 v99, v134, v135
    buffer_store_dwordx4 v[96:99], v63, s[40:43], s101 offen offset:0 sc1
    v_mul_f32 v144, v144, v152
    v_mul_f32 v145, v145, v153
    v_mul_f32 v146, v146, v154
    v_mul_f32 v147, v147, v155
    v_mul_f32 v148, v148, v156
    v_mul_f32 v149, v149, v157
    v_mul_f32 v150, v150, v158
    v_mul_f32 v151, v151, v159
    v_cvt_pk_bf16_f32 v100, v144, v145
    v_cvt_pk_bf16_f32 v101, v146, v147
    v_cvt_pk_bf16_f32 v102, v148, v149
    v_cvt_pk_bf16_f32 v103, v150, v151
    buffer_store_dwordx4 v[100:103], v63, s[40:43], s101 offen offset:1024 sc1
    v_mul_f32 v160, v160, v168
    v_mul_f32 v161, v161, v169
    v_mul_f32 v162, v162, v170
    v_mul_f32 v163, v163, v171
    v_mul_f32 v164, v164, v172
    v_mul_f32 v165, v165, v173
    v_mul_f32 v166, v166, v174
    v_mul_f32 v167, v167, v175
    v_cvt_pk_bf16_f32 v104, v160, v161
    v_cvt_pk_bf16_f32 v105, v162, v163
    v_cvt_pk_bf16_f32 v106, v164, v165
    v_cvt_pk_bf16_f32 v107, v166, v167
    s_add_u32 s101, s101, s45
    buffer_store_dwordx4 v[104:107], v63, s[40:43], s101 offen offset:2048 sc1
    v_mul_f32 v176, v176, v184
    v_mul_f32 v177, v177, v185
    v_mul_f32 v178, v178, v186
    v_mul_f32 v179, v179, v187
    v_mul_f32 v180, v180, v188
    v_mul_f32 v181, v181, v189
    v_mul_f32 v182, v182, v190
    v_mul_f32 v183, v183, v191
    v_cvt_pk_bf16_f32 v108, v176, v177
    v_cvt_pk_bf16_f32 v109, v178, v179
    v_cvt_pk_bf16_f32 v110, v180, v181
    v_cvt_pk_bf16_f32 v111, v182, v183
    buffer_store_dwordx4 v[108:111], v63, s[40:43], s100 offen offset:0 sc1
    v_mul_f32 v192, v192, v200
    v_mul_f32 v193, v193, v201
    v_mul_f32 v194, v194, v202
    v_mul_f32 v195, v195, v203
    v_mul_f32 v196, v196, v204
    v_mul_f32 v197, v197, v205
    v_mul_f32 v198, v198, v206
    v_mul_f32 v199, v199, v207
    v_cvt_pk_bf16_f32 v112, v192, v193
    v_cvt_pk_bf16_f32 v113, v194, v195
    v_cvt_pk_bf16_f32 v114, v196, v197
    v_cvt_pk_bf16_f32 v115, v198, v199
    buffer_store_dwordx4 v[112:115], v63, s[40:43], s100 offen offset:1024 sc1
    v_mul_f32 v208, v208, v216
    v_mul_f32 v209, v209, v217
    v_mul_f32 v210, v210, v218
    v_mul_f32 v211, v211, v219
    v_mul_f32 v212, v212, v220
    v_mul_f32 v213, v213, v221
    v_mul_f32 v214, v214, v222
    v_mul_f32 v215, v215, v223
    v_cvt_pk_bf16_f32 v116, v208, v209
    v_cvt_pk_bf16_f32 v117, v210, v211
    v_cvt_pk_bf16_f32 v118, v212, v213
    v_cvt_pk_bf16_f32 v119, v214, v215
    s_add_u32 s100, s100, s45
    buffer_store_dwordx4 v[116:119], v63, s[40:43], s100 offen offset:2048 sc1
    v_cvt_pk_bf16_f32 v64, v224, v225
    v_cvt_pk_bf16_f32 v65, v226, v227
    v_cvt_pk_bf16_f32 v66, v228, v229
    v_cvt_pk_bf16_f32 v67, v230, v231
    v_cvt_pk_bf16_f32 v68, v232, v233
    v_cvt_pk_bf16_f32 v69, v234, v235
    v_cvt_pk_bf16_f32 v70, v236, v237
    v_cvt_pk_bf16_f32 v71, v238, v239
    v_mfma_f32_32x32x16_bf16 v[208:223], v[32:35], v[64:67], 0
    v_mfma_f32_32x32x16_bf16 v[224:239], v[40:43], v[64:67], 0
    v_mfma_f32_32x32x16_bf16 v[208:223], v[36:39], v[68:71], v[208:223]
    v_mfma_f32_32x32x16_bf16 v[224:239], v[44:47], v[68:71], v[224:239]
    v_lshrrev_b32 v58, 2, v1
    v_and_b32 v58, 3, v58
    v_lshl_add_u32 v59, v4, 2, v58
    v_lshlrev_b32 v59, 7, v59
    v_lshl_add_u32 v59, v7, 5, v59
    v_and_b32 v61, 3, v1
    v_lshl_add_u32 v59, v61, 3, v59
    s_mul_i32 s44, s48, 26624
    v_add_u32 v59, s44, v59
    v_lshrrev_b32 v58, 1, v58
    v_xor_b32 v58, s48, v58
    v_lshl_add_u32 v8, v58, 6, v59
    v_xor_b32 v9, 64, v8
    v_add_u32 v10, 53248, v8
    v_add_u32 v11, 53248, v9
    v_add_u32 v12, 106496, v8
    v_add_u32 v13, 106496, v9
    ds_read_b64_tr_b16 v[128:129], v12 offset:0
    ds_read_b64_tr_b16 v[130:131], v12 offset:1024
    ds_read_b64_tr_b16 v[132:133], v13 offset:0
    ds_read_b64_tr_b16 v[134:135], v13 offset:1024
    ds_read_b64_tr_b16 v[136:137], v12 offset:2048
    ds_read_b64_tr_b16 v[138:139], v12 offset:3072
    ds_read_b64_tr_b16 v[140:141], v13 offset:2048
    ds_read_b64_tr_b16 v[142:143], v13 offset:3072
    ds_read_b64_tr_b16 v[144:145], v12 offset:4096
    ds_read_b64_tr_b16 v[146:147], v12 offset:5120
    ds_read_b64_tr_b16 v[148:149], v13 offset:4096
    ds_read_b64_tr_b16 v[150:151], v13 offset:5120
    ds_read_b64_tr_b16 v[152:153], v12 offset:6144
    ds_read_b64_tr_b16 v[154:155], v12 offset:7168
    ds_read_b64_tr_b16 v[156:157], v13 offset:6144
    ds_read_b64_tr_b16 v[158:159], v13 offset:7168
    ds_read_b64_tr_b16 v[160:161], v12 offset:8192
    ds_read_b64_tr_b16 v[162:163], v12 offset:9216
    ds_read_b64_tr_b16 v[164:165], v13 offset:8192
    ds_read_b64_tr_b16 v[166:167], v13 offset:9216
    ds_read_b64_tr_b16 v[168:169], v12 offset:10240
    ds_read_b64_tr_b16 v[170:171], v12 offset:11264
    ds_read_b64_tr_b16 v[172:173], v13 offset:10240
    ds_read_b64_tr_b16 v[174:175], v13 offset:11264
    v_lshlrev_b32 v60, 10, v4
    v_lshl_add_u32 v60, v7, 8, v60
    v_and_b32 v61, 15, v1
    v_lshl_add_u32 v60, v61, 4, v60
    s_lshl_b32 s44, s46, 2
    s_add_u32 s44, s44, 75776
    v_add_u32 v60, s44, v60
    v_permlane16_swap_b32 v208, v209
    v_permlane16_swap_b32 v224, v225
    v_permlane16_swap_b32 v210, v211
    v_permlane16_swap_b32 v226, v227
    v_permlane16_swap_b32 v212, v213
    v_permlane16_swap_b32 v228, v229
    v_permlane16_swap_b32 v214, v215
    v_permlane16_swap_b32 v230, v231
    v_permlane16_swap_b32 v216, v217
    v_permlane16_swap_b32 v232, v233
    v_permlane16_swap_b32 v218, v219
    v_permlane16_swap_b32 v234, v235
    v_permlane16_swap_b32 v220, v221
    v_permlane16_swap_b32 v236, v237
    v_permlane16_swap_b32 v222, v223
    v_permlane16_swap_b32 v238, v239
    v_sub_f32 v208, v208, v225
    v_add_f32 v209, v209, v224
    v_cvt_pk_bf16_f32 v224, v208, v209
    ds_write_b32 v60, v224 offset:0
    v_sub_f32 v210, v210, v227
    v_add_f32 v211, v211, v226
    v_cvt_pk_bf16_f32 v226, v210, v211
    ds_write_b32 v60, v226 offset:512
    v_sub_f32 v212, v212, v229
    v_add_f32 v213, v213, v228
    v_cvt_pk_bf16_f32 v228, v212, v213
    ds_write_b32 v60, v228 offset:2048
    v_sub_f32 v214, v214, v231
    v_add_f32 v215, v215, v230
    v_cvt_pk_bf16_f32 v230, v214, v215
    ds_write_b32 v60, v230 offset:2560
    v_sub_f32 v216, v216, v233
    v_add_f32 v217, v217, v232
    v_cvt_pk_bf16_f32 v232, v216, v217
    ds_write_b32 v60, v232 offset:26624
    v_sub_f32 v218, v218, v235
    v_add_f32 v219, v219, v234
    v_cvt_pk_bf16_f32 v234, v218, v219
    ds_write_b32 v60, v234 offset:27136
    v_sub_f32 v220, v220, v237
    v_add_f32 v221, v221, v236
    v_cvt_pk_bf16_f32 v236, v220, v221
    ds_write_b32 v60, v236 offset:28672
    v_sub_f32 v222, v222, v239
    v_add_f32 v223, v223, v238
    v_cvt_pk_bf16_f32 v238, v222, v223
    ds_write_b32 v60, v238 offset:29184
    s_waitcnt lgkmcnt(0)
    s_barrier
    s_setprio 0
    v_add_u32 v5, s53, v3
    v_sub_u32 v6, 512, v5
    v_and_b32 v6, 255, v6
    s_sub_u32 s44, 32, s23
    s_and_b32 s44, s44, 31
    s_mov_b32 s47, 0xba000000
    s_cmp_lt_u32 s22, 4
    s_cselect_b32 s54, s23, s44
    s_cselect_b64 vcc, -1, 0
    s_cselect_b32 s47, 0x3a000000, s47
    v_cndmask_b32 v6, v6, v5, vcc
    v_lshlrev_b32 v6, 4, v6
    v_lshl_add_u32 v6, v4, 17, v6
    v_cmp_eq_u32 vcc, 0, v5
    v_mov_b32 v61, 1073741824
    s_nop 0
    v_cndmask_b32 v6, v6, v61, vcc
    s_lshl_b32 s54, s54, 12
    s_add_u32 s54, s54, 6291456
    s_mul_i32 s51, s52, 86
    s_mul_i32 s44, s48, 43
    s_add_u32 s51, s51, s44
    s_lshl_b32 s51, s51, 10
    v_lshlrev_b32 v14, 4, v1
    v_mul_f32 v2, v2, v2
    v_mov_b32 v16, 0
    v_mov_b32 v17, 0
    v_mov_b32 v18, 0
    v_mov_b32 v19, 0
    v_mov_b32 v20, 0
    v_mov_b32 v21, 0
    v_mov_b32 v22, 0
    v_mov_b32 v23, 0
    v_mov_b32 v24, 0
    v_mov_b32 v25, 0
    v_mov_b32 v26, 0
    v_mov_b32 v27, 0
    v_mov_b32 v28, 0
    v_mov_b32 v29, 0
    v_mov_b32 v30, 0
    v_mov_b32 v31, 0
    v_mov_b32 v32, 0
    v_mov_b32 v33, 0
    v_mov_b32 v34, 0
    v_mov_b32 v35, 0
    v_mov_b32 v36, 0
    v_mov_b32 v37, 0
    v_mov_b32 v38, 0
    v_mov_b32 v39, 0
    v_mov_b32 v40, 0
    v_mov_b32 v41, 0
    v_mov_b32 v42, 0
    v_mov_b32 v43, 0
    v_mov_b32 v44, 0
    v_mov_b32 v45, 0
    v_mov_b32 v46, 0
    v_mov_b32 v47, 0
    v_lshl_add_u32 v232, v3, 6, s52
    v_cvt_f32_u32 v232, v232
    v_mul_f32 v232, s47, v232
    v_lshlrev_b32 v233, 1, v4
    v_cvt_f32_u32 v233, v233
    v_mul_f32 v233, v232, v233
    v_fmamk_f32 v234, v232, 0x00000000, v233
    v_cos_f32 v235, v234
    v_sin_f32 v236, v234
    v_fmamk_f32 v237, v232, 0x3f800000, v233
    v_cos_f32 v238, v237
    v_sin_f32 v239, v237
    v_cvt_pk_bf16_f32 v176, v235, v236
    v_cvt_pk_bf16_f32 v177, v238, v239
    v_fmamk_f32 v234, v232, 0x42000000, v233
    v_cos_f32 v235, v234
    v_sin_f32 v236, v234
    v_fmamk_f32 v237, v232, 0x42040000, v233
    v_cos_f32 v238, v237
    v_sin_f32 v239, v237
    v_cvt_pk_bf16_f32 v178, v235, v236
    v_cvt_pk_bf16_f32 v179, v238, v239
    v_fmamk_f32 v234, v232, 0x40800000, v233
    v_cos_f32 v235, v234
    v_sin_f32 v236, v234
    v_fmamk_f32 v237, v232, 0x40a00000, v233
    v_cos_f32 v238, v237
    v_sin_f32 v239, v237
    v_cvt_pk_bf16_f32 v180, v235, v236
    v_cvt_pk_bf16_f32 v181, v238, v239
    v_fmamk_f32 v234, v232, 0x42100000, v233
    v_cos_f32 v235, v234
    v_sin_f32 v236, v234
    v_fmamk_f32 v237, v232, 0x42140000, v233
    v_cos_f32 v238, v237
    v_sin_f32 v239, v237
    v_cvt_pk_bf16_f32 v182, v235, v236
    v_cvt_pk_bf16_f32 v183, v238, v239
    v_fmamk_f32 v234, v232, 0x41000000, v233
    v_cos_f32 v235, v234
    v_sin_f32 v236, v234
    v_fmamk_f32 v237, v232, 0x41100000, v233
    v_cos_f32 v238, v237
    v_sin_f32 v239, v237
    v_cvt_pk_bf16_f32 v184, v235, v236
    v_cvt_pk_bf16_f32 v185, v238, v239
    v_fmamk_f32 v234, v232, 0x42200000, v233
    v_cos_f32 v235, v234
    v_sin_f32 v236, v234
    v_fmamk_f32 v237, v232, 0x42240000, v233
    v_cos_f32 v238, v237
    v_sin_f32 v239, v237
    v_cvt_pk_bf16_f32 v186, v235, v236
    v_cvt_pk_bf16_f32 v187, v238, v239
    v_fmamk_f32 v234, v232, 0x41400000, v233
    v_cos_f32 v235, v234
    v_sin_f32 v236, v234
    v_fmamk_f32 v237, v232, 0x41500000, v233
    v_cos_f32 v238, v237
    v_sin_f32 v239, v237
    v_cvt_pk_bf16_f32 v188, v235, v236
    v_cvt_pk_bf16_f32 v189, v238, v239
    v_fmamk_f32 v234, v232, 0x42300000, v233
    v_cos_f32 v235, v234
    v_sin_f32 v236, v234
    v_fmamk_f32 v237, v232, 0x42340000, v233
    v_cos_f32 v238, v237
    v_sin_f32 v239, v237
    v_cvt_pk_bf16_f32 v190, v235, v236
    v_cvt_pk_bf16_f32 v191, v238, v239
    v_fmamk_f32 v234, v232, 0x41800000, v233
    v_cos_f32 v235, v234
    v_sin_f32 v236, v234
    v_fmamk_f32 v237, v232, 0x41880000, v233
    v_cos_f32 v238, v237
    v_sin_f32 v239, v237
    v_cvt_pk_bf16_f32 v192, v235, v236
    v_cvt_pk_bf16_f32 v193, v238, v239
    v_fmamk_f32 v234, v232, 0x42400000, v233
    v_cos_f32 v235, v234
    v_sin_f32 v236, v234
    v_fmamk_f32 v237, v232, 0x42440000, v233
    v_cos_f32 v238, v237
    v_sin_f32 v239, v237
    v_cvt_pk_bf16_f32 v194, v235, v236
    v_cvt_pk_bf16_f32 v195, v238, v239
    v_fmamk_f32 v234, v232, 0x41a00000, v233
    v_cos_f32 v235, v234
    v_sin_f32 v236, v234
    v_fmamk_f32 v237, v232, 0x41a80000, v233
    v_cos_f32 v238, v237
    v_sin_f32 v239, v237
    v_cvt_pk_bf16_f32 v196, v235, v236
    v_cvt_pk_bf16_f32 v197, v238, v239
    v_fmamk_f32 v234, v232, 0x42500000, v233
    v_cos_f32 v235, v234
    v_sin_f32 v236, v234
    v_fmamk_f32 v237, v232, 0x42540000, v233
    v_cos_f32 v238, v237
    v_sin_f32 v239, v237
    v_cvt_pk_bf16_f32 v198, v235, v236
    v_cvt_pk_bf16_f32 v199, v238, v239
    v_fmamk_f32 v234, v232, 0x41c00000, v233
    v_cos_f32 v235, v234
    v_sin_f32 v236, v234
    v_fmamk_f32 v237, v232, 0x41c80000, v233
    v_cos_f32 v238, v237
    v_sin_f32 v239, v237
    v_cvt_pk_bf16_f32 v200, v235, v236
    v_cvt_pk_bf16_f32 v201, v238, v239
    v_fmamk_f32 v234, v232, 0x42600000, v233
    v_cos_f32 v235, v234
    v_sin_f32 v236, v234
    v_fmamk_f32 v237, v232, 0x42640000, v233
    v_cos_f32 v238, v237
    v_sin_f32 v239, v237
    v_cvt_pk_bf16_f32 v202, v235, v236
    v_cvt_pk_bf16_f32 v203, v238, v239
    v_fmamk_f32 v234, v232, 0x41e00000, v233
    v_cos_f32 v235, v234
    v_sin_f32 v236, v234
    v_fmamk_f32 v237, v232, 0x41e80000, v233
    v_cos_f32 v238, v237
    v_sin_f32 v239, v237
    v_cvt_pk_bf16_f32 v204, v235, v236
    v_cvt_pk_bf16_f32 v205, v238, v239
    v_fmamk_f32 v234, v232, 0x42700000, v233
    v_cos_f32 v235, v234
    v_sin_f32 v236, v234
    v_fmamk_f32 v237, v232, 0x42740000, v233
    v_cos_f32 v238, v237
    v_sin_f32 v239, v237
    v_cvt_pk_bf16_f32 v206, v235, v236
    v_cvt_pk_bf16_f32 v207, v238, v239
    s_waitcnt vmcnt(0)
    s_mov_b64 exec, 1
    buffer_store_dword v252, v251, s[40:43], s60 offen
    s_mov_b64 exec, -1
    s_cmp_eq_u32 s46, 0
    s_cbranch_scc1 K_c0
    v_mov_b32 v58, 163328
    s_mov_b32 s63, 0
K_s2:
    ds_read_b32 v60, v58
    s_add_u32 s63, s63, 1
    s_waitcnt lgkmcnt(0)
    v_cmp_eq_u32 vcc, 0, v60
    s_cbranch_vccz K_s2_ok
    s_sleep 1
    s_cmp_lt_u32 s63, 25600000
    s_cbranch_scc1 K_s2
K_s2_ok:
    s_branch K_c1
K_c0:
    v_lshlrev_b32 v60, 2, v1
    s_add_u32 s45, s60, 65536
    s_mov_b32 s63, 0
K_p2_f:
    buffer_load_dword v62, v60, s[40:43], s60 offen sc1
    s_add_u32 s63, s63, 1
    s_waitcnt vmcnt(0)
    v_cmp_ne_u32 vcc, s62, v62
    s_cbranch_vccz K_p2_ok
    s_cmp_lt_u32 s63, 3000
    s_cbranch_scc1 K_p2_f
    v_and_b32 v61, 3, v1
    v_lshlrev_b32 v61, 2, v61
    s_lshl_b32 s44, s17, 4
    v_add_u32 v61, s44, v61
    s_mov_b32 s63, 0
K_p2own_s:
    buffer_load_dword v62, v61, s[40:43], s60 offen sc1
    s_add_u32 s63, s63, 1
    s_waitcnt vmcnt(0)
    v_cmp_ne_u32 vcc, s62, v62
    s_cbranch_vccz K_p2own_ok
    s_sleep 4
    s_cmp_lt_u32 s63, 400000
    s_cbranch_scc1 K_p2own_s
K_p2own_ok:
    s_mov_b64 exec, 15
    buffer_store_dword v252, v61, s[40:43], s45 offen sc1
    s_mov_b64 exec, -1
    s_mov_b32 s63, 0
K_p2_s:
    buffer_load_dword v62, v60, s[40:43], s45 offen sc1
    s_add_u32 s63, s63, 1
    s_waitcnt vmcnt(0)
    v_cmp_ne_u32 vcc, s62, v62
    s_cbranch_vccz K_p2_ok
    s_sleep 4
    s_cmp_lt_u32 s63, 400000
    s_cbranch_scc1 K_p2_s
K_p2_ok:
    v_mov_b32 v58, 163328
    v_mov_b32 v59, 1
    ds_write_b32 v58, v59
K_c1:
    buffer_load_dwordx4 v[64:67], v14, s[40:43], s51 offen offset:0 sc1
    buffer_load_dwordx4 v[68:71], v14, s[40:43], s51 offen offset:1024 sc1
    buffer_load_dwordx4 v[72:75], v14, s[40:43], s51 offen offset:2048 sc1
    buffer_load_dwordx4 v[76:79], v14, s[40:43], s51 offen offset:3072 sc1
    s_add_u32 s51, s51, 4096
    buffer_load_dwordx4 v[80:83], v14, s[40:43], s51 offen offset:0 sc1
    buffer_load_dwordx4 v[84:87], v14, s[40:43], s51 offen offset:1024 sc1
    buffer_load_dwordx4 v[88:91], v14, s[40:43], s51 offen offset:2048 sc1
    buffer_load_dwordx4 v[92:95], v14, s[40:43], s51 offen offset:3072 sc1
    s_add_u32 s51, s51, 4096
    buffer_load_dwordx4 v[96:99], v14, s[40:43], s51 offen offset:0 sc1
    buffer_load_dwordx4 v[100:103], v14, s[40:43], s51 offen offset:1024 sc1
    buffer_load_dwordx4 v[104:107], v14, s[40:43], s51 offen offset:2048 sc1
    buffer_load_dwordx4 v[108:111], v14, s[40:43], s51 offen offset:3072 sc1
    s_add_u32 s51, s51, 4096
    s_waitcnt vmcnt(11)
    v_mfma_f32_32x32x16_bf16 v[32:47], v[132:135], v[64:67], v[32:47]
    v_mfma_f32_32x32x16_bf16 v[16:31], v[128:131], v[64:67], v[16:31]
    buffer_load_dwordx4 v[112:115], v14, s[40:43], s51 offen offset:0 sc1
    s_waitcnt vmcnt(11)
    v_mfma_f32_32x32x16_bf16 v[32:47], v[140:143], v[68:71], v[32:47]
    v_mfma_f32_32x32x16_bf16 v[16:31], v[136:139], v[68:71], v[16:31]
    buffer_load_dwordx4 v[116:119], v14, s[40:43], s51 offen offset:1024 sc1
    s_waitcnt vmcnt(11)
    v_mfma_f32_32x32x16_bf16 v[32:47], v[148:151], v[72:75], v[32:47]
    v_mfma_f32_32x32x16_bf16 v[16:31], v[144:147], v[72:75], v[16:31]
    buffer_load_dwordx4 v[120:123], v14, s[40:43], s51 offen offset:2048 sc1
    s_waitcnt vmcnt(11)
    v_mfma_f32_32x32x16_bf16 v[32:47], v[156:159], v[76:79], v[32:47]
    v_mfma_f32_32x32x16_bf16 v[16:31], v[152:155], v[76:79], v[16:31]
    buffer_load_dwordx4 v[124:127], v14, s[40:43], s51 offen offset:3072 sc1
    s_add_u32 s51, s51, 4096
    s_waitcnt vmcnt(11)
    v_mfma_f32_32x32x16_bf16 v[32:47], v[164:167], v[80:83], v[32:47]
    ds_read_b64_tr_b16 v[212:213], v13 offset:12288
    ds_read_b64_tr_b16 v[214:215], v13 offset:13312
    v_mfma_f32_32x32x16_bf16 v[16:31], v[160:163], v[80:83], v[16:31]
    ds_read_b64_tr_b16 v[208:209], v12 offset:12288
    ds_read_b64_tr_b16 v[210:211], v12 offset:13312
    buffer_load_dwordx4 v[64:67], v14, s[40:43], s51 offen offset:0 sc1
    s_waitcnt vmcnt(11)
    v_mfma_f32_32x32x16_bf16 v[32:47], v[172:175], v[84:87], v[32:47]
    ds_read_b64_tr_b16 v[220:221], v13 offset:14336
    ds_read_b64_tr_b16 v[222:223], v13 offset:15360
    v_mfma_f32_32x32x16_bf16 v[16:31], v[168:171], v[84:87], v[16:31]
    ds_read_b64_tr_b16 v[216:217], v12 offset:14336
    ds_read_b64_tr_b16 v[218:219], v12 offset:15360
    buffer_load_dwordx4 v[68:71], v14, s[40:43], s51 offen offset:1024 sc1
    s_waitcnt vmcnt(11) lgkmcnt(6)
    v_mfma_f32_32x32x16_bf16 v[32:47], v[212:215], v[88:91], v[32:47]
    ds_read_b64_tr_b16 v[228:229], v13 offset:16384
    ds_read_b64_tr_b16 v[230:231], v13 offset:17408
    s_waitcnt lgkmcnt(6)
    v_mfma_f32_32x32x16_bf16 v[16:31], v[208:211], v[88:91], v[16:31]
    ds_read_b64_tr_b16 v[224:225], v12 offset:16384
    ds_read_b64_tr_b16 v[226:227], v12 offset:17408
    buffer_load_dwordx4 v[72:75], v14, s[40:43], s51 offen offset:2048 sc1
    s_waitcnt vmcnt(11) lgkmcnt(6)
    v_mfma_f32_32x32x16_bf16 v[32:47], v[220:223], v[92:95], v[32:47]
    ds_read_b64_tr_b16 v[212:213], v13 offset:18432
    ds_read_b64_tr_b16 v[214:215], v13 offset:19456
    v_lshlrev_b32 v160, 16, v240
    v_lshlrev_b32 v162, 16, v241
    s_waitcnt lgkmcnt(6)
    v_mfma_f32_32x32x16_bf16 v[16:31], v[216:219], v[92:95], v[16:31]
    ds_read_b64_tr_b16 v[208:209], v12 offset:18432
    ds_read_b64_tr_b16 v[210:211], v12 offset:19456
    buffer_load_dwordx4 v[76:79], v14, s[40:43], s51 offen offset:3072 sc1
    s_add_u32 s51, s51, 4096
    s_waitcnt vmcnt(11) lgkmcnt(6)
    v_mfma_f32_32x32x16_bf16 v[32:47], v[228:231], v[96:99], v[32:47]
    ds_read_b64_tr_b16 v[220:221], v13 offset:20480
    ds_read_b64_tr_b16 v[222:223], v13 offset:21504
    v_lshlrev_b32 v164, 16, v242
    v_lshlrev_b32 v166, 16, v243
    s_waitcnt lgkmcnt(6)
    v_mfma_f32_32x32x16_bf16 v[16:31], v[224:227], v[96:99], v[16:31]
    ds_read_b64_tr_b16 v[216:217], v12 offset:20480
    ds_read_b64_tr_b16 v[218:219], v12 offset:21504
    buffer_load_dwordx4 v[80:83], v14, s[40:43], s51 offen offset:0 sc1
    s_waitcnt vmcnt(11) lgkmcnt(6)
    v_mfma_f32_32x32x16_bf16 v[32:47], v[212:215], v[100:103], v[32:47]
    ds_read_b64_tr_b16 v[228:229], v13 offset:22528
    ds_read_b64_tr_b16 v[230:231], v13 offset:23552
    v_lshlrev_b32 v168, 16, v244
    v_lshlrev_b32 v170, 16, v245
    s_waitcnt lgkmcnt(6)
    v_mfma_f32_32x32x16_bf16 v[16:31], v[208:211], v[100:103], v[16:31]
    ds_read_b64_tr_b16 v[224:225], v12 offset:22528
    ds_read_b64_tr_b16 v[226:227], v12 offset:23552
    buffer_load_dwordx4 v[84:87], v14, s[40:43], s51 offen offset:1024 sc1
    s_waitcnt vmcnt(11) lgkmcnt(6)
    v_mfma_f32_32x32x16_bf16 v[32:47], v[220:223], v[104:107], v[32:47]
    ds_read_b64_tr_b16 v[212:213], v13 offset:24576
    ds_read_b64_tr_b16 v[214:215], v13 offset:25600
    v_lshlrev_b32 v172, 16, v246
    v_lshlrev_b32 v174, 16, v247
    s_waitcnt lgkmcnt(6)
    v_mfma_f32_32x32x16_bf16 v[16:31], v[216:219], v[104:107], v[16:31]
    ds_read_b64_tr_b16 v[208:209], v12 offset:24576
    ds_read_b64_tr_b16 v[210:211], v12 offset:25600
    buffer_load_dwordx4 v[88:91], v14, s[40:43], s51 offen offset:2048 sc1
    s_waitcnt vmcnt(11) lgkmcnt(6)
    v_mfma_f32_32x32x16_bf16 v[32:47], v[228:231], v[108:111], v[32:47]
    ds_read_b64_tr_b16 v[220:221], v9 offset:0
    ds_read_b64_tr_b16 v[222:223], v9 offset:1024
    v_and_b32 v161, 0xffff0000, v240
    v_and_b32 v163, 0xffff0000, v241
    s_waitcnt lgkmcnt(6)
    v_mfma_f32_32x32x16_bf16 v[16:31], v[224:227], v[108:111], v[16:31]
    ds_read_b64_tr_b16 v[216:217], v8 offset:0
    ds_read_b64_tr_b16 v[218:219], v8 offset:1024
    buffer_load_dwordx4 v[92:95], v14, s[40:43], s51 offen offset:3072 sc1
    s_add_u32 s51, s51, 4096
    s_waitcnt vmcnt(11) lgkmcnt(6)
    v_mfma_f32_32x32x16_bf16 v[32:47], v[212:215], v[112:115], v[32:47]
    ds_read_b64_tr_b16 v[228:229], v9 offset:2048
    ds_read_b64_tr_b16 v[230:231], v9 offset:3072
    v_and_b32 v165, 0xffff0000, v242
    v_and_b32 v167, 0xffff0000, v243
    s_waitcnt lgkmcnt(6)
    v_mfma_f32_32x32x16_bf16 v[16:31], v[208:211], v[112:115], v[16:31]
    ds_read_b64_tr_b16 v[224:225], v8 offset:2048
    ds_read_b64_tr_b16 v[226:227], v8 offset:3072
    buffer_load_dwordx4 v[96:99], v14, s[40:43], s51 offen offset:0 sc1
    s_waitcnt vmcnt(11) lgkmcnt(6)
    v_mfma_f32_32x32x16_bf16 v[32:47], v[220:223], v[116:119], v[32:47]
    ds_read_b64_tr_b16 v[212:213], v9 offset:4096
    ds_read_b64_tr_b16 v[214:215], v9 offset:5120
    v_and_b32 v169, 0xffff0000, v244
    v_and_b32 v171, 0xffff0000, v245
    s_waitcnt lgkmcnt(6)
    v_mfma_f32_32x32x16_bf16 v[16:31], v[216:219], v[116:119], v[16:31]
    ds_read_b64_tr_b16 v[208:209], v8 offset:4096
    ds_read_b64_tr_b16 v[210:211], v8 offset:5120
    buffer_load_dwordx4 v[100:103], v14, s[40:43], s51 offen offset:1024 sc1
    s_waitcnt vmcnt(11) lgkmcnt(6)
    v_mfma_f32_32x32x16_bf16 v[32:47], v[228:231], v[120:123], v[32:47]
    ds_read_b64_tr_b16 v[220:221], v9 offset:6144
    ds_read_b64_tr_b16 v[222:223], v9 offset:7168
    v_and_b32 v173, 0xffff0000, v246
    v_and_b32 v175, 0xffff0000, v247
    s_waitcnt lgkmcnt(6)
    v_mfma_f32_32x32x16_bf16 v[16:31], v[224:227], v[120:123], v[16:31]
    ds_read_b64_tr_b16 v[216:217], v8 offset:6144
    ds_read_b64_tr_b16 v[218:219], v8 offset:7168
    buffer_load_dwordx4 v[104:107], v14, s[40:43], s51 offen offset:2048 sc1
    s_waitcnt vmcnt(11) lgkmcnt(6)
    v_mfma_f32_32x32x16_bf16 v[32:47], v[212:215], v[124:127], v[32:47]
    ds_read_b64_tr_b16 v[228:229], v9 offset:8192
    ds_read_b64_tr_b16 v[230:231], v9 offset:9216
    s_waitcnt lgkmcnt(6)
    v_mfma_f32_32x32x16_bf16 v[16:31], v[208:211], v[124:127], v[16:31]
    ds_read_b64_tr_b16 v[224:225], v8 offset:8192
    ds_read_b64_tr_b16 v[226:227], v8 offset:9216
    buffer_load_dwordx4 v[108:111], v14, s[40:43], s51 offen offset:3072 sc1
    s_add_u32 s51, s51, 4096
    s_waitcnt vmcnt(11) lgkmcnt(6)
    v_mfma_f32_32x32x16_bf16 v[32:47], v[220:223], v[64:67], v[32:47]
    ds_read_b64_tr_b16 v[212:213], v9 offset:10240
    ds_read_b64_tr_b16 v[214:215], v9 offset:11264
    s_waitcnt lgkmcnt(6)
    v_mfma_f32_32x32x16_bf16 v[16:31], v[216:219], v[64:67], v[16:31]
    ds_read_b64_tr_b16 v[208:209], v8 offset:10240
    ds_read_b64_tr_b16 v[210:211], v8 offset:11264
    buffer_load_dwordx4 v[112:115], v14, s[40:43], s51 offen offset:0 sc1
    s_waitcnt vmcnt(11) lgkmcnt(6)
    v_mfma_f32_32x32x16_bf16 v[32:47], v[228:231], v[68:71], v[32:47]
    ds_read_b64_tr_b16 v[220:221], v9 offset:12288
    ds_read_b64_tr_b16 v[222:223], v9 offset:13312
    s_waitcnt lgkmcnt(6)
    v_mfma_f32_32x32x16_bf16 v[16:31], v[224:227], v[68:71], v[16:31]
    ds_read_b64_tr_b16 v[216:217], v8 offset:12288
    ds_read_b64_tr_b16 v[218:219], v8 offset:13312
    buffer_load_dwordx4 v[116:119], v14, s[40:43], s51 offen offset:1024 sc1
    s_waitcnt vmcnt(11) lgkmcnt(6)
    v_mfma_f32_32x32x16_bf16 v[32:47], v[212:215], v[72:75], v[32:47]
    v_mov_b32 v232, 163336
    s_mov_b32 s63, 0
K_s3:
    ds_read_b64 v[234:235], v232
    s_add_u32 s63, s63, 1
    s_waitcnt lgkmcnt(0)
    v_and_b32 v234, v234, v235
    v_cmp_eq_u32 vcc, 0, v234
    s_cbranch_vccz K_s3_ok
    s_sleep 1
    s_cmp_lt_u32 s63, 25600000
    s_cbranch_scc1 K_s3
K_s3_ok:
    ds_read_b64_tr_b16 v[228:229], v9 offset:14336
    ds_read_b64_tr_b16 v[230:231], v9 offset:15360
    buffer_load_dwordx4 v[128:131], v6, s[40:43], s54 offen sc1
    s_add_u32 s54, s54, 0x40000
    s_waitcnt lgkmcnt(6)
    v_mfma_f32_32x32x16_bf16 v[16:31], v[208:211], v[72:75], v[16:31]
    ds_read_b64_tr_b16 v[224:225], v8 offset:14336
    ds_read_b64_tr_b16 v[226:227], v8 offset:15360
    buffer_load_dwordx4 v[120:123], v14, s[40:43], s51 offen offset:2048 sc1
    s_waitcnt vmcnt(12) lgkmcnt(6)
    v_mfma_f32_32x32x16_bf16 v[32:47], v[220:223], v[76:79], v[32:47]
    ds_read_b64_tr_b16 v[212:213], v9 offset:16384
    ds_read_b64_tr_b16 v[214:215], v9 offset:17408
    buffer_load_dwordx4 v[132:135], v6, s[40:43], s54 offen sc1
    s_add_u32 s54, s54, 0x40000
    s_waitcnt lgkmcnt(6)
    v_mfma_f32_32x32x16_bf16 v[16:31], v[216:219], v[76:79], v[16:31]
    ds_read_b64_tr_b16 v[208:209], v8 offset:16384
    ds_read_b64_tr_b16 v[210:211], v8 offset:17408
    buffer_load_dwordx4 v[124:127], v14, s[40:43], s51 offen offset:3072 sc1
    s_add_u32 s51, s51, 4096
    s_waitcnt vmcnt(13) lgkmcnt(6)
    v_mfma_f32_32x32x16_bf16 v[32:47], v[228:231], v[80:83], v[32:47]
    ds_read_b64_tr_b16 v[220:221], v9 offset:18432
    ds_read_b64_tr_b16 v[222:223], v9 offset:19456
    buffer_load_dwordx4 v[136:139], v6, s[40:43], s54 offen sc1
    s_add_u32 s54, s54, 0x40000
    s_waitcnt lgkmcnt(6)
    v_mfma_f32_32x32x16_bf16 v[16:31], v[224:227], v[80:83], v[16:31]
    ds_read_b64_tr_b16 v[216:217], v8 offset:18432
    ds_read_b64_tr_b16 v[218:219], v8 offset:19456
    buffer_load_dwordx4 v[64:67], v14, s[40:43], s51 offen offset:0 sc1
    s_waitcnt vmcnt(14) lgkmcnt(6)
    v_mfma_f32_32x32x16_bf16 v[32:47], v[212:215], v[84:87], v[32:47]
    ds_read_b64_tr_b16 v[228:229], v9 offset:20480
    ds_read_b64_tr_b16 v[230:231], v9 offset:21504
    buffer_load_dwordx4 v[140:143], v6, s[40:43], s54 offen sc1
    s_add_u32 s54, s54, 0x40000
    s_waitcnt lgkmcnt(6)
    v_mfma_f32_32x32x16_bf16 v[16:31], v[208:211], v[84:87], v[16:31]
    ds_read_b64_tr_b16 v[224:225], v8 offset:20480
    ds_read_b64_tr_b16 v[226:227], v8 offset:21504
    buffer_load_dwordx4 v[68:71], v14, s[40:43], s51 offen offset:1024 sc1
    s_waitcnt vmcnt(15) lgkmcnt(6)
    v_mfma_f32_32x32x16_bf16 v[32:47], v[220:223], v[88:91], v[32:47]
    ds_read_b64_tr_b16 v[212:213], v9 offset:22528
    ds_read_b64_tr_b16 v[214:215], v9 offset:23552
    buffer_load_dwordx4 v[144:147], v6, s[40:43], s54 offen sc1
    s_add_u32 s54, s54, 0x40000
    s_waitcnt lgkmcnt(6)
    v_mfma_f32_32x32x16_bf16 v[16:31], v[216:219], v[88:91], v[16:31]
    ds_read_b64_tr_b16 v[208:209], v8 offset:22528
    ds_read_b64_tr_b16 v[210:211], v8 offset:23552
    buffer_load_dwordx4 v[72:75], v14, s[40:43], s51 offen offset:2048 sc1
    s_waitcnt vmcnt(16) lgkmcnt(6)
    v_mfma_f32_32x32x16_bf16 v[32:47], v[228:231], v[92:95], v[32:47]
    ds_read_b64_tr_b16 v[220:221], v9 offset:24576
    ds_read_b64_tr_b16 v[222:223], v9 offset:25600
    buffer_load_dwordx4 v[148:151], v6, s[40:43], s54 offen sc1
    s_add_u32 s54, s54, 0x40000
    s_waitcnt lgkmcnt(6)
    v_mfma_f32_32x32x16_bf16 v[16:31], v[224:227], v[92:95], v[16:31]
    ds_read_b64_tr_b16 v[216:217], v8 offset:24576
    ds_read_b64_tr_b16 v[218:219], v8 offset:25600
    buffer_load_dwordx4 v[76:79], v14, s[40:43], s51 offen offset:3072 sc1
    s_add_u32 s51, s51, 4096
    s_waitcnt vmcnt(17) lgkmcnt(6)
    v_mfma_f32_32x32x16_bf16 v[32:47], v[212:215], v[96:99], v[32:47]
    v_mov_b32 v232, 163344
    s_mov_b32 s63, 0
K_sw:
    ds_read_b64 v[234:235], v232
    s_add_u32 s63, s63, 1
    s_waitcnt lgkmcnt(0)
    v_and_b32 v234, v234, v235
    v_cmp_eq_u32 vcc, 0, v234
    s_cbranch_vccz K_sw_ok
    s_sleep 1
    s_cmp_lt_u32 s63, 25600000
    s_cbranch_scc1 K_sw
K_sw_ok:
    ds_read_b64_tr_b16 v[228:229], v11 offset:0
    ds_read_b64_tr_b16 v[230:231], v11 offset:1024
    buffer_load_dwordx4 v[152:155], v6, s[40:43], s54 offen sc1
    s_add_u32 s54, s54, 0x40000
    s_waitcnt lgkmcnt(6)
    v_mfma_f32_32x32x16_bf16 v[16:31], v[208:211], v[96:99], v[16:31]
    ds_read_b64_tr_b16 v[224:225], v10 offset:0
    ds_read_b64_tr_b16 v[226:227], v10 offset:1024
    buffer_load_dwordx4 v[80:83], v14, s[40:43], s51 offen offset:0 sc1
    s_waitcnt vmcnt(18) lgkmcnt(6)
    v_mfma_f32_32x32x16_bf16 v[32:47], v[220:223], v[100:103], v[32:47]
    ds_read_b64_tr_b16 v[212:213], v11 offset:2048
    ds_read_b64_tr_b16 v[214:215], v11 offset:3072
    buffer_load_dwordx4 v[156:159], v6, s[40:43], s54 offen sc1
    s_add_u32 s54, s54, 0x40000
    s_waitcnt lgkmcnt(6)
    v_mfma_f32_32x32x16_bf16 v[16:31], v[216:219], v[100:103], v[16:31]
    ds_read_b64_tr_b16 v[208:209], v10 offset:2048
    ds_read_b64_tr_b16 v[210:211], v10 offset:3072
    buffer_load_dwordx4 v[84:87], v14, s[40:43], s51 offen offset:1024 sc1
    s_waitcnt vmcnt(19) lgkmcnt(6)
    v_mfma_f32_32x32x16_bf16 v[32:47], v[228:231], v[104:107], v[32:47]
    ds_read_b64_tr_b16 v[220:221], v11 offset:4096
    ds_read_b64_tr_b16 v[222:223], v11 offset:5120
    s_waitcnt lgkmcnt(6)
    v_mfma_f32_32x32x16_bf16 v[16:31], v[224:227], v[104:107], v[16:31]
    ds_read_b64_tr_b16 v[216:217], v10 offset:4096
    ds_read_b64_tr_b16 v[218:219], v10 offset:5120
    buffer_load_dwordx4 v[88:91], v14, s[40:43], s51 offen offset:2048 sc1
    s_waitcnt vmcnt(19) lgkmcnt(6)
    v_mfma_f32_32x32x16_bf16 v[32:47], v[212:215], v[108:111], v[32:47]
    ds_read_b64_tr_b16 v[228:229], v11 offset:6144
    ds_read_b64_tr_b16 v[230:231], v11 offset:7168
    s_waitcnt lgkmcnt(6)
    v_mfma_f32_32x32x16_bf16 v[16:31], v[208:211], v[108:111], v[16:31]
    ds_read_b64_tr_b16 v[224:225], v10 offset:6144
    ds_read_b64_tr_b16 v[226:227], v10 offset:7168
    buffer_load_dwordx4 v[92:95], v14, s[40:43], s51 offen offset:3072 sc1
    s_add_u32 s51, s51, 4096
    s_waitcnt vmcnt(19) lgkmcnt(6)
    v_mfma_f32_32x32x16_bf16 v[32:47], v[220:223], v[112:115], v[32:47]
    ds_read_b64_tr_b16 v[212:213], v11 offset:8192
    ds_read_b64_tr_b16 v[214:215], v11 offset:9216
    s_waitcnt lgkmcnt(6)
    v_mfma_f32_32x32x16_bf16 v[16:31], v[216:219], v[112:115], v[16:31]
    ds_read_b64_tr_b16 v[208:209], v10 offset:8192
    ds_read_b64_tr_b16 v[210:211], v10 offset:9216
    buffer_load_dwordx4 v[96:99], v14, s[40:43], s51 offen offset:0 sc1
    s_waitcnt vmcnt(19) lgkmcnt(6)
    v_mfma_f32_32x32x16_bf16 v[32:47], v[228:231], v[116:119], v[32:47]
    ds_read_b64_tr_b16 v[220:221], v11 offset:10240
    ds_read_b64_tr_b16 v[222:223], v11 offset:11264
    s_waitcnt lgkmcnt(6)
    v_mfma_f32_32x32x16_bf16 v[16:31], v[224:227], v[116:119], v[16:31]
    ds_read_b64_tr_b16 v[216:217], v10 offset:10240
    ds_read_b64_tr_b16 v[218:219], v10 offset:11264
    buffer_load_dwordx4 v[100:103], v14, s[40:43], s51 offen offset:1024 sc1
    s_waitcnt vmcnt(18) lgkmcnt(6)
    v_mfma_f32_32x32x16_bf16 v[32:47], v[212:215], v[120:123], v[32:47]
    s_barrier
    ds_read_b64_tr_b16 v[228:229], v11 offset:12288
    ds_read_b64_tr_b16 v[230:231], v11 offset:13312
    s_waitcnt lgkmcnt(6)
    v_mfma_f32_32x32x16_bf16 v[16:31], v[208:211], v[120:123], v[16:31]
    ds_read_b64_tr_b16 v[224:225], v10 offset:12288
    ds_read_b64_tr_b16 v[226:227], v10 offset:13312
    buffer_load_dwordx4 v[104:107], v14, s[40:43], s51 offen offset:2048 sc1
    s_waitcnt vmcnt(17) lgkmcnt(6)
    v_mfma_f32_32x32x16_bf16 v[32:47], v[220:223], v[124:127], v[32:47]
    ds_read_b64_tr_b16 v[212:213], v11 offset:14336
    ds_read_b64_tr_b16 v[214:215], v11 offset:15360
    s_waitcnt lgkmcnt(6)
    v_mfma_f32_32x32x16_bf16 v[16:31], v[216:219], v[124:127], v[16:31]
    ds_read_b64_tr_b16 v[208:209], v10 offset:14336
    ds_read_b64_tr_b16 v[210:211], v10 offset:15360
    s_waitcnt vmcnt(15) lgkmcnt(6)
    v_mfma_f32_32x32x16_bf16 v[32:47], v[228:231], v[64:67], v[32:47]
    ds_read_b64_tr_b16 v[220:221], v11 offset:16384
    ds_read_b64_tr_b16 v[222:223], v11 offset:17408
    s_waitcnt lgkmcnt(6)
    v_mfma_f32_32x32x16_bf16 v[16:31], v[224:227], v[64:67], v[16:31]
    ds_read_b64_tr_b16 v[216:217], v10 offset:16384
    ds_read_b64_tr_b16 v[218:219], v10 offset:17408
    s_waitcnt vmcnt(13) lgkmcnt(6)
    v_mfma_f32_32x32x16_bf16 v[32:47], v[212:215], v[68:71], v[32:47]
    ds_read_b64_tr_b16 v[228:229], v11 offset:18432
    ds_read_b64_tr_b16 v[230:231], v11 offset:19456
    s_waitcnt lgkmcnt(6)
    v_mfma_f32_32x32x16_bf16 v[16:31], v[208:211], v[68:71], v[16:31]
    ds_read_b64_tr_b16 v[224:225], v10 offset:18432
    ds_read_b64_tr_b16 v[226:227], v10 offset:19456
    s_waitcnt vmcnt(11) lgkmcnt(6)
    v_mfma_f32_32x32x16_bf16 v[32:47], v[220:223], v[72:75], v[32:47]
    ds_read_b64_tr_b16 v[212:213], v11 offset:20480
    ds_read_b64_tr_b16 v[214:215], v11 offset:21504
    s_waitcnt lgkmcnt(6)
    v_mfma_f32_32x32x16_bf16 v[16:31], v[216:219], v[72:75], v[16:31]
    ds_read_b64_tr_b16 v[208:209], v10 offset:20480
    ds_read_b64_tr_b16 v[210:211], v10 offset:21504
    s_waitcnt vmcnt(9) lgkmcnt(6)
    v_mfma_f32_32x32x16_bf16 v[32:47], v[228:231], v[76:79], v[32:47]
    ds_read_b64_tr_b16 v[220:221], v13 offset:0
    ds_read_b64_tr_b16 v[222:223], v13 offset:1024
    s_waitcnt lgkmcnt(6)
    v_mfma_f32_32x32x16_bf16 v[16:31], v[224:227], v[76:79], v[16:31]
    ds_read_b64_tr_b16 v[216:217], v12 offset:0
    ds_read_b64_tr_b16 v[218:219], v12 offset:1024
    s_waitcnt vmcnt(7) lgkmcnt(6)
    v_mfma_f32_32x32x16_bf16 v[32:47], v[212:215], v[80:83], v[32:47]
    ds_read_b64_tr_b16 v[228:229], v13 offset:2048
    ds_read_b64_tr_b16 v[230:231], v13 offset:3072
    s_waitcnt lgkmcnt(6)
    v_mfma_f32_32x32x16_bf16 v[16:31], v[208:211], v[80:83], v[16:31]
    ds_read_b64_tr_b16 v[224:225], v12 offset:2048
    ds_read_b64_tr_b16 v[226:227], v12 offset:3072
    s_waitcnt vmcnt(5) lgkmcnt(6)
    v_mfma_f32_32x32x16_bf16 v[48:63], v[128:131], v[176:179], 0
    v_mfma_f32_32x32x16_bf16 v[48:63], v[132:135], v[180:183], v[48:63]
    v_mfma_f32_32x32x16_bf16 v[48:63], v[136:139], v[184:187], v[48:63]
    v_mfma_f32_32x32x16_bf16 v[48:63], v[140:143], v[188:191], v[48:63]
    v_mfma_f32_32x32x16_bf16 v[48:63], v[144:147], v[192:195], v[48:63]
    v_mfma_f32_32x32x16_bf16 v[48:63], v[148:151], v[196:199], v[48:63]
    v_mfma_f32_32x32x16_bf16 v[48:63], v[152:155], v[200:203], v[48:63]
    v_mfma_f32_32x32x16_bf16 v[48:63], v[156:159], v[204:207], v[48:63]
    v_mfma_f32_32x32x16_bf16 v[32:47], v[220:223], v[84:87], v[32:47]
    ds_read_b64_tr_b16 v[212:213], v13 offset:4096
    ds_read_b64_tr_b16 v[214:215], v13 offset:5120
    s_waitcnt lgkmcnt(6)
    v_mfma_f32_32x32x16_bf16 v[16:31], v[216:219], v[84:87], v[16:31]
    ds_read_b64_tr_b16 v[208:209], v12 offset:4096
    ds_read_b64_tr_b16 v[210:211], v12 offset:5120
    s_waitcnt vmcnt(4) lgkmcnt(6)
    v_mfma_f32_32x32x16_bf16 v[32:47], v[228:231], v[88:91], v[32:47]
    ds_read_b64_tr_b16 v[220:221], v13 offset:6144
    ds_read_b64_tr_b16 v[222:223], v13 offset:7168
    s_nop 0
    v_mul_f32 v48, v48, v2
    v_mul_f32 v49, v49, v2
    s_waitcnt lgkmcnt(6)
    v_mfma_f32_32x32x16_bf16 v[16:31], v[224:227], v[88:91], v[16:31]
    ds_read_b64_tr_b16 v[216:217], v12 offset:6144
    ds_read_b64_tr_b16 v[218:219], v12 offset:7168
    v_mul_f32 v50, v50, v2
    s_waitcnt vmcnt(3) lgkmcnt(6)
    v_mfma_f32_32x32x16_bf16 v[32:47], v[212:215], v[92:95], v[32:47]
    ds_read_b64_tr_b16 v[228:229], v13 offset:8192
    ds_read_b64_tr_b16 v[230:231], v13 offset:9216
    v_mul_f32 v51, v51, v2
    v_mul_f32 v52, v52, v2
    s_waitcnt lgkmcnt(6)
    v_mfma_f32_32x32x16_bf16 v[16:31], v[208:211], v[92:95], v[16:31]
    ds_read_b64_tr_b16 v[224:225], v12 offset:8192
    ds_read_b64_tr_b16 v[226:227], v12 offset:9216
    v_mul_f32 v53, v53, v2
    s_waitcnt vmcnt(2) lgkmcnt(6)
    v_mfma_f32_32x32x16_bf16 v[32:47], v[220:223], v[96:99], v[32:47]
    ds_read_b64_tr_b16 v[212:213], v13 offset:10240
    ds_read_b64_tr_b16 v[214:215], v13 offset:11264
    v_mul_f32 v54, v54, v2
    v_mul_f32 v55, v55, v2
    s_waitcnt lgkmcnt(6)
    v_mfma_f32_32x32x16_bf16 v[16:31], v[216:219], v[96:99], v[16:31]
    ds_read_b64_tr_b16 v[208:209], v12 offset:10240
    ds_read_b64_tr_b16 v[210:211], v12 offset:11264
    v_mul_f32 v56, v56, v2
    s_waitcnt vmcnt(1) lgkmcnt(6)
    v_mfma_f32_32x32x16_bf16 v[32:47], v[228:231], v[100:103], v[32:47]
    v_mul_f32 v57, v57, v2
    v_mul_f32 v58, v58, v2
    s_waitcnt lgkmcnt(4)
    v_mfma_f32_32x32x16_bf16 v[16:31], v[224:227], v[100:103], v[16:31]
    v_mul_f32 v59, v59, v2
    s_waitcnt vmcnt(0) lgkmcnt(2)
    v_mfma_f32_32x32x16_bf16 v[32:47], v[212:215], v[104:107], v[32:47]
    v_mul_f32 v60, v60, v2
    v_mul_f32 v61, v61, v2
    s_waitcnt lgkmcnt(0)
    v_mfma_f32_32x32x16_bf16 v[16:31], v[208:211], v[104:107], v[16:31]
    v_mul_f32 v62, v62, v2
    v_mul_f32 v63, v63, v2
    v_mul_f32 v2, 0xbfb8aa3b, v2
    s_lshl_b32 s44, s46, 12
    s_xor_b32 s45, s44, 8192
    v_add_u32 v12, s44, v14
    v_add_u32 v13, s45, v14
    s_lshl_b32 s44, s46, 11
    s_add_u32 s44, s44, 16384
    v_add_u32 v8, s44, v250
    v_add_u32 v15, s44, v14
    v_xor_b32 v9, 16, v8
    v_xor_b32 v10, 32, v8
    v_xor_b32 v11, 48, v8
    ds_write_b128 v12, v[32:35] offset:0
    ds_write_b128 v12, v[36:39] offset:1024
    ds_write_b128 v12, v[40:43] offset:2048
    ds_write_b128 v12, v[44:47] offset:3072
    s_waitcnt lgkmcnt(0)
    s_barrier
    ds_read_b128 v[32:35], v13 offset:0
    ds_read_b128 v[36:39], v13 offset:1024
    ds_read_b128 v[40:43], v13 offset:2048
    ds_read_b128 v[44:47], v13 offset:3072
    v_mov_b32 v3, v2
    v_mov_b32 v4, 1.0
    v_mov_b32 v5, 1.0
    s_waitcnt lgkmcnt(3)
    v_pk_add_f32 v[16:17], v[16:17], v[32:33]
    v_pk_add_f32 v[18:19], v[18:19], v[34:35]
    v_pk_mul_f32 v[64:65], v[16:17], v[2:3]
    v_pk_mul_f32 v[66:67], v[18:19], v[2:3]
    v_exp_f32 v64, v64
    v_exp_f32 v65, v65
    v_exp_f32 v66, v66
    v_exp_f32 v67, v67
    v_pk_mul_f32 v[16:17], v[16:17], v[48:49]
    v_pk_mul_f32 v[18:19], v[18:19], v[50:51]
    v_pk_add_f32 v[64:65], v[64:65], v[4:5]
    v_pk_add_f32 v[66:67], v[66:67], v[4:5]
    v_rcp_f32 v64, v64
    v_rcp_f32 v65, v65
    v_rcp_f32 v66, v66
    v_rcp_f32 v67, v67
    v_pk_fma_f32 v[16:17], v[16:17], v[64:65], v[160:161]
    v_pk_fma_f32 v[18:19], v[18:19], v[66:67], v[162:163]
    v_cvt_pk_bf16_f32 v232, v16, v17
    v_cvt_pk_bf16_f32 v233, v18, v19
    ds_write_b64 v8, v[232:233]
    s_waitcnt lgkmcnt(3)
    v_pk_add_f32 v[20:21], v[20:21], v[36:37]
    v_pk_add_f32 v[22:23], v[22:23], v[38:39]
    v_pk_mul_f32 v[68:69], v[20:21], v[2:3]
    v_pk_mul_f32 v[70:71], v[22:23], v[2:3]
    v_exp_f32 v68, v68
    v_exp_f32 v69, v69
    v_exp_f32 v70, v70
    v_exp_f32 v71, v71
    v_pk_mul_f32 v[20:21], v[20:21], v[52:53]
    v_pk_mul_f32 v[22:23], v[22:23], v[54:55]
    v_pk_add_f32 v[68:69], v[68:69], v[4:5]
    v_pk_add_f32 v[70:71], v[70:71], v[4:5]
    v_rcp_f32 v68, v68
    v_rcp_f32 v69, v69
    v_rcp_f32 v70, v70
    v_rcp_f32 v71, v71
    v_pk_fma_f32 v[20:21], v[20:21], v[68:69], v[164:165]
    v_pk_fma_f32 v[22:23], v[22:23], v[70:71], v[166:167]
    v_cvt_pk_bf16_f32 v234, v20, v21
    v_cvt_pk_bf16_f32 v235, v22, v23
    ds_write_b64 v9, v[234:235]
    s_waitcnt lgkmcnt(3)
    v_pk_add_f32 v[24:25], v[24:25], v[40:41]
    v_pk_add_f32 v[26:27], v[26:27], v[42:43]
    v_pk_mul_f32 v[72:73], v[24:25], v[2:3]
    v_pk_mul_f32 v[74:75], v[26:27], v[2:3]
    v_exp_f32 v72, v72
    v_exp_f32 v73, v73
    v_exp_f32 v74, v74
    v_exp_f32 v75, v75
    v_pk_mul_f32 v[24:25], v[24:25], v[56:57]
    v_pk_mul_f32 v[26:27], v[26:27], v[58:59]
    v_pk_add_f32 v[72:73], v[72:73], v[4:5]
    v_pk_add_f32 v[74:75], v[74:75], v[4:5]
    v_rcp_f32 v72, v72
    v_rcp_f32 v73, v73
    v_rcp_f32 v74, v74
    v_rcp_f32 v75, v75
    v_pk_fma_f32 v[24:25], v[24:25], v[72:73], v[168:169]
    v_pk_fma_f32 v[26:27], v[26:27], v[74:75], v[170:171]
    v_cvt_pk_bf16_f32 v236, v24, v25
    v_cvt_pk_bf16_f32 v237, v26, v27
    ds_write_b64 v10, v[236:237]
    s_waitcnt lgkmcnt(3)
    v_pk_add_f32 v[28:29], v[28:29], v[44:45]
    v_pk_add_f32 v[30:31], v[30:31], v[46:47]
    v_pk_mul_f32 v[76:77], v[28:29], v[2:3]
    v_pk_mul_f32 v[78:79], v[30:31], v[2:3]
    v_exp_f32 v76, v76
    v_exp_f32 v77, v77
    v_exp_f32 v78, v78
    v_exp_f32 v79, v79
    v_pk_mul_f32 v[28:29], v[28:29], v[60:61]
    v_pk_mul_f32 v[30:31], v[30:31], v[62:63]
    v_pk_add_f32 v[76:77], v[76:77], v[4:5]
    v_pk_add_f32 v[78:79], v[78:79], v[4:5]
    v_rcp_f32 v76, v76
    v_rcp_f32 v77, v77
    v_rcp_f32 v78, v78
    v_rcp_f32 v79, v79
    v_pk_fma_f32 v[28:29], v[28:29], v[76:77], v[172:173]
    v_pk_fma_f32 v[30:31], v[30:31], v[78:79], v[174:175]
    v_cvt_pk_bf16_f32 v238, v28, v29
    v_cvt_pk_bf16_f32 v239, v30, v31
    ds_write_b64 v11, v[238:239]
    s_waitcnt lgkmcnt(0)
    ds_read_b128 v[64:67], v15
    ds_read_b128 v[68:71], v15 offset:1024
    s_waitcnt lgkmcnt(1)
    buffer_store_dwordx4 v[64:67], v248, s[32:35], 0 offen
    s_waitcnt lgkmcnt(0)
    buffer_store_dwordx4 v[68:71], v249, s[32:35], 0 offen
K_end:
    s_endpgm
K_stop:
.section .rodata,"a"
.p2align 6
.amdhsa_kernel recurrent_scan__spectral_fnet__glu_gated_bilinear__prompt_kernel
  .amdhsa_next_free_vgpr 256
  .amdhsa_next_free_sgpr 102
  .amdhsa_accum_offset 256
  .amdhsa_group_segment_fixed_size 0
  .amdhsa_kernarg_size 96
  .amdhsa_user_sgpr_count 2
  .amdhsa_user_sgpr_kernarg_segment_ptr 1
  .amdhsa_system_sgpr_workgroup_id_x 1
.end_amdhsa_kernel
```
